```python
import torch

def _softmax(x, axis=-1):
    return torch.softmax(x, dim=axis)
def _gelu(x):
    return torch.nn.functional.gelu(x, approximate="tanh")
def _silu(x):
    return torch.nn.functional.silu(x)
def _sigmoid(x):
    return torch.sigmoid(x)
def _layernorm(x, axis=-1, eps=1e-5):
    m = x.mean(dim=axis, keepdim=True)
    v = x.var(dim=axis, keepdim=True, unbiased=False)
    return (x - m) / torch.sqrt(v + eps)
def _scatter_add(tgt, idx, src, axis=0):
    return tgt.clone().index_add_(axis, idx, src)
def _segment_sum(src, seg, n):
    out = torch.zeros((n,) + src.shape[1:], dtype=src.dtype)
    return out.index_add_(0, seg, src)
def _pad(x, pw):
    flat = tuple(v for pair in reversed(pw) for v in pair)
    return torch.nn.functional.pad(x, flat)

kernel_name = 'gated_mix__gqa_block_cached__dense_activation_silu__decode'

def setup_inputs():

    _w = (lambda a: (lambda t: t.to(torch.bfloat16) if t.is_floating_point() else t)(torch.as_tensor(a)))
    def _A_setup():
        B, Sq, D = 2, 1, 448
        Hq, Hkv, Sk, Dh = 16, 8, 32768, 256
        assert Hq % Hkv == 0, (Hq, Hkv)
        return {
            "x": _w((lambda *s: torch.randn(*s, dtype=torch.bfloat16) * 0.05)(B, Sq, D)),
            "k_cache": _w((lambda *s: torch.randn(*s, dtype=torch.bfloat16) * 6.4)(B, Hkv, Sk, Dh)),
            "v_cache": _w((lambda *s: torch.randn(*s, dtype=torch.bfloat16) * 0.8)(B, Hkv, Sk, Dh)),
            "wq": _w((lambda *s: torch.randn(*s, dtype=torch.bfloat16) * 6.4)(D, Hq * Dh) * (D ** -0.5)),
            "wo": _w((lambda *s: torch.randn(*s, dtype=torch.bfloat16) * 0.8)(Hq * Dh, D) * ((Hq * Dh) ** -0.5)),
        }
    _A_in = _A_setup()

    def _B_setup():
        B, S, D, F = 2, 1, 448, 1792
        return {
            "x": _w((lambda *s: torch.randn(*s, dtype=torch.bfloat16) * 0.05)(B, S, D)),
            "w1": _w((lambda *s: torch.randn(*s, dtype=torch.bfloat16) * 12.8)(D, F) * (D ** -0.5)),
            "w2": _w((lambda *s: torch.randn(*s, dtype=torch.bfloat16) * 0.2)(F, D) * (F ** -0.5)),
        }
    _B_in = _B_setup()

    return {
        "A_x": _A_in["x"],
        "A_k_cache": _A_in["k_cache"],
        "A_v_cache": _A_in["v_cache"],
        "A_wq": _A_in["wq"],
        "A_wo": _A_in["wo"],
        "B_x": _B_in["x"],
        "B_w1": _B_in["w1"],
        "B_w2": _B_in["w2"],
        "gate_w": _w((lambda *s: torch.randn(*s, dtype=torch.bfloat16) * 0.2)(448) * 16.0),
    }

def reference(A_x, A_k_cache, A_v_cache, A_wq, A_wo, B_x, B_w1, B_w2, gate_w):
    def _A_ref(x, k_cache, v_cache, wq, wo):
        B, Sq, D = x.shape
        Hq, Dh = 16, 256
        Hkv = k_cache.shape[1]
        rep = Hq // Hkv
        q = (lambda x, *d: x.permute(*d))((x @ wq).reshape(B, Sq, Hq, Dh), 0, 2, 1, 3)
        k = (lambda x, n, axis: torch.repeat_interleave(x, n, dim=axis))(k_cache, rep, axis=1)
        v = (lambda x, n, axis: torch.repeat_interleave(x, n, dim=axis))(v_cache, rep, axis=1)
        scores = torch.einsum("bhqd,bhkd->bhqk", q, k) * (Dh ** -0.5)
        p = _softmax(scores, axis=-1)
        o = torch.einsum("bhqk,bhkd->bhqd", p, v)
        return (lambda x, *d: x.permute(*d))(o, 0, 2, 1, 3).reshape(B, Sq, Hq * Dh) @ wo

    def _B_ref(x, w1, w2):
        h = torch.einsum("bsd,df->bsf", x, w1)
        h = _silu(h)
        out = torch.einsum("bsf,fd->bsd", h, w2)
        return out

    x = A_x
    g = _sigmoid((x * gate_w).sum(-1, keepdims=True))
    a = _A_ref(x, A_k_cache, A_v_cache, A_wq, A_wo)
    b = _B_ref(x, B_w1, B_w2)
    return g * a + (1 - g) * b
```

```asm
; @launch grid=(256,1,1) block=(128,1,1) lds=160256
.amdgcn_target "amdgcn-amd-amdhsa--gfx950"
.text
.globl gated_mix__gqa_block_cached__dense_activation_silu__decode_kernel
.p2align 8
.type gated_mix__gqa_block_cached__dense_activation_silu__decode_kernel,@function
gated_mix__gqa_block_cached__dense_activation_silu__decode_kernel:
    s_cmp_ge_u32 s2, 256
    s_cbranch_scc1 .Lexit
    s_load_dwordx16 s[36:51], s[0:1], 0
    s_load_dwordx8 s[52:59], s[0:1], 64
    s_cmp_ge_u32 s2, 16
    s_cbranch_scc1 .Lnopf
    s_getpc_b64 s[4:5]
.Lpc:
    v_lshlrev_b32 v9, 7, v0
    v_add_u32 v10, 0x0, v9
    v_min_u32 v10, .Lexit-.Lpc, v10
    global_load_dword v249, v10, s[4:5]
    v_add_u32 v10, 0x4000, v9
    v_min_u32 v10, .Lexit-.Lpc, v10
    global_load_dword v248, v10, s[4:5]
.Lnopf:
    v_lshrrev_b32 v1, 6, v0
    v_lshlrev_b32 v8, 2, v0
    v_readfirstlane_b32 s3, v1
    v_add_u32 v8, 159744, v8
    v_mov_b32 v14, 0
    ds_write_b32 v8, v14
    v_and_b32 v1, 63, v0
    s_cmp_eq_u32 s3, 0
    s_cbranch_scc1 .Lldr
.Lcons:
    v_lshlrev_b32 v56, 4, v1
    v_lshrrev_b32 v58, 3, v1
    v_and_b32 v59, 7, v1
    v_lshlrev_b32 v57, 13, v58
    v_lshl_add_u32 v57, v59, 4, v57
    v_mul_u32_u24 v58, 3584, v58
    v_lshl_add_u32 v58, v59, 4, v58
    v_mov_b32 v59, 0
    v_and_b32 v2, 15, v1
    v_lshrrev_b32 v3, 4, v1
    v_bfe_u32 v4, v1, 2, 2
    v_and_b32 v5, 3, v1
    s_and_b32 s4, s2, 3
    s_mul_i32 s5, s4, 917504
    s_lshr_b32 s6, s2, 2
    s_lshl_b32 s6, s6, 7
    s_add_u32 s5, s5, s6
    s_and_b32 s20, s2, 7
    s_mul_i32 s21, s20, 200704
    s_lshr_b32 s22, s2, 3
    s_lshl_b32 s23, s22, 7
    s_add_u32 s21, s21, s23
    s_cmp_lt_u32 s2, 224
    s_cselect_b32 s21, s21, 0x200000
    s_waitcnt lgkmcnt(0)
    s_mov_b32 s16, s58
    s_mov_b32 s17, s59
    s_mov_b32 s18, 0x700000
    s_mov_b32 s19, 0x20000
    s_mov_b32 s8, s36
    s_mov_b32 s9, s37
    s_mov_b32 s10, 0x700
    s_mov_b32 s11, 0x20000
    s_mov_b32 s12, s42
    s_mov_b32 s13, s43
    s_mov_b32 s14, 0x380000
    s_mov_b32 s15, 0x20000
    buffer_load_dword v6, v59, s[16:19], 0 offen
    s_mov_b32 m0, 155648
    s_nop 0
    buffer_load_dwordx4 v56, s[8:11], 0 offen lds
    buffer_load_dwordx4 v56, s[8:11], 0 offen offset:1024 lds
    s_mov_b32 m0, 131072
    s_add_u32 s6, s5, 0x0
    buffer_load_dwordx4 v57, s[12:15], s6 offen nt lds
    s_mov_b32 m0, 132096
    s_add_u32 s6, s5, 0x10000
    buffer_load_dwordx4 v57, s[12:15], s6 offen nt lds
    s_mov_b32 m0, 133120
    s_add_u32 s6, s5, 0x20000
    buffer_load_dwordx4 v57, s[12:15], s6 offen nt lds
    s_mov_b32 m0, 134144
    s_add_u32 s6, s5, 0x30000
    buffer_load_dwordx4 v57, s[12:15], s6 offen nt lds
    s_mov_b32 m0, 135168
    s_add_u32 s6, s5, 0x40000
    buffer_load_dwordx4 v57, s[12:15], s6 offen nt lds
    s_mov_b32 m0, 136192
    s_add_u32 s6, s5, 0x50000
    buffer_load_dwordx4 v57, s[12:15], s6 offen nt lds
    s_mov_b32 m0, 137216
    s_add_u32 s6, s5, 0x60000
    buffer_load_dwordx4 v57, s[12:15], s6 offen nt lds
    s_mov_b32 m0, 138240
    s_add_u32 s6, s5, 0x70000
    buffer_load_dwordx4 v57, s[12:15], s6 offen nt lds
    s_mov_b32 m0, 139264
    s_add_u32 s6, s5, 0x80000
    buffer_load_dwordx4 v57, s[12:15], s6 offen nt lds
    s_mov_b32 m0, 140288
    s_add_u32 s6, s5, 0x90000
    buffer_load_dwordx4 v57, s[12:15], s6 offen nt lds
    s_mov_b32 m0, 141312
    s_add_u32 s6, s5, 0xa0000
    buffer_load_dwordx4 v57, s[12:15], s6 offen nt lds
    s_mov_b32 m0, 142336
    s_add_u32 s6, s5, 0xb0000
    buffer_load_dwordx4 v57, s[12:15], s6 offen nt lds
    s_mov_b32 m0, 143360
    s_add_u32 s6, s5, 0xc0000
    buffer_load_dwordx4 v57, s[12:15], s6 offen nt lds
    s_mov_b32 m0, 144384
    s_add_u32 s6, s5, 0xd0000
    buffer_load_dwordx4 v57, s[12:15], s6 offen nt lds
    s_mov_b32 s24, s48
    s_mov_b32 s25, s49
    s_mov_b32 s26, 0x188000
    s_mov_b32 s27, 0x20000
    s_mov_b32 s32, s52
    s_mov_b32 s33, s53
    s_mov_b32 s34, 0x380
    s_mov_b32 s35, 0x20000
    s_mov_b32 m0, 157696
    s_mov_b32 s60, s54
    s_mov_b32 s61, s55
    s_mov_b32 s62, 0x700
    s_mov_b32 s63, 0x20000
    buffer_load_dwordx4 v56, s[32:35], 0 offen lds
    s_mov_b32 m0, 114688
    s_add_u32 s6, s21, 0x0
    buffer_load_dwordx4 v58, s[24:27], s6 offen nt lds
    s_mov_b32 m0, 115712
    s_add_u32 s6, s21, 0x7000
    buffer_load_dwordx4 v58, s[24:27], s6 offen nt lds
    s_mov_b32 m0, 116736
    s_add_u32 s6, s21, 0xe000
    buffer_load_dwordx4 v58, s[24:27], s6 offen nt lds
    s_mov_b32 m0, 117760
    s_add_u32 s6, s21, 0x15000
    buffer_load_dwordx4 v58, s[24:27], s6 offen nt lds
    s_mov_b32 m0, 118784
    s_add_u32 s6, s21, 0x1c000
    buffer_load_dwordx4 v58, s[24:27], s6 offen nt lds
    s_mov_b32 m0, 119808
    s_add_u32 s6, s21, 0x23000
    buffer_load_dwordx4 v58, s[24:27], s6 offen nt lds
    s_mov_b32 m0, 120832
    s_add_u32 s6, s21, 0x2a000
    buffer_load_dwordx4 v58, s[24:27], s6 offen nt lds
    s_mov_b32 m0, 121856
    s_mov_b32 s6, 0x200000
    buffer_load_dwordx4 v58, s[24:27], s6 offen nt lds
    s_barrier
    s_branch .Lcons2
.Lldr:
    s_lshr_b32 s17, s2, 3
    s_and_b32 s17, s17, 1
    s_lshr_b32 s18, s2, 4
    s_lshl_b32 s18, s18, 3
    s_lshr_b32 s19, s2, 4
    s_xor_b32 s19, s19, s2
    s_and_b32 s19, s19, 7
    s_or_b32 s18, s18, s19
    s_and_b32 s18, s2, 7
    s_lshl_b32 s18, s18, 4
    s_bfe_u32 s19, s2, 0x40003
    s_or_b32 s18, s18, s19
    s_and_b32 s19, s2, 0x80
    s_or_b32 s18, s18, s19
    s_lshr_b32 s18, s18, 1
    s_lshl_b32 s16, s18, 21
    s_mul_i32 s17, s17, 32768
    s_add_u32 s16, s16, s17
    v_lshrrev_b32 v3, 5, v1
    v_and_b32 v5, 31, v1
    v_lshlrev_b32 v4, 1, v3
    v_xor_b32 v5, v5, v4
    v_lshlrev_b32 v5, 4, v5
    v_lshl_add_u32 v20, v3, 9, v5
    v_xor_b32 v21, 64, v20
    v_xor_b32 v22, 128, v20
    v_xor_b32 v23, 192, v20
    v_mov_b32 v7, 160000
    v_lshlrev_b32 v24, 4, v1
    s_mov_b32 s20, -7
    s_mov_b32 s22, 0
    s_mov_b32 s27, s16
    s_mov_b32 s24, 0
    s_mov_b32 s25, 4194304
    s_and_b32 s28, s2, 7
    s_lshl_b32 s28, s28, 5
    s_lshr_b32 s29, s2, 3
    s_or_b32 s28, s28, s29
    s_lshr_b32 s4, s28, 3
    s_lshl_b32 s4, s4, 7
    s_bfe_u32 s5, s28, 0x20001
    s_lshl_b32 s5, s5, 5
    s_add_u32 s4, s4, s5
    s_and_b32 s5, s28, 1
    s_lshl_b32 s5, s5, 3
    s_add_u32 s4, s4, s5
    s_mul_i32 s4, s4, 896
    s_mul_i32 s6, s2, 7168
    s_waitcnt lgkmcnt(0)
    s_mov_b32 s8, s38
    s_mov_b32 s9, s39
    s_mov_b32 s10, 0x10000000
    s_mov_b32 s11, 0x20000
    s_mov_b32 s60, s44
    s_mov_b32 s61, s45
    s_mov_b32 s62, 0x380000
    s_mov_b32 s63, 0x20000
    s_mov_b32 s64, s50
    s_mov_b32 s65, s51
    s_mov_b32 s66, 0x188000
    s_mov_b32 s67, 0x20000
    s_mov_b32 s72, s58
    s_mov_b32 s73, s59
    s_mov_b32 s74, 0x700000
    s_mov_b32 s75, 0x20000
    s_lshr_b32 s76, s28, 5
    s_lshl_b32 s76, s76, 16
    s_and_b32 s77, s28, 31
    s_lshl_b32 s77, s77, 7
    s_add_u32 s76, s76, s77
    s_add_u32 s76, s76, 0x100000
    s_add_u32 s77, s76, 0x8000
    s_add_u32 s78, s76, 0x80000
    s_add_u32 s79, s76, 0x88000
    s_mul_i32 s80, s28, 5120
    s_add_u32 s80, s80, 0x200000
    s_add_u32 s81, s80, 0x1000
    s_mov_b32 s48, 0x00030003
    s_mov_b32 s49, 0x00300030
    s_mov_b32 s50, 0x03000300
    s_mov_b32 s51, 0x30003000
    s_mov_b32 s29, 40
    v_add_u32 v25, 155648, v24
    s_barrier
    s_mov_b32 s26, 57
    s_add_u32 m0, s22, 0x0
    s_add_u32 s23, s16, 0x0
    s_nop 0
    buffer_load_dwordx4 v20, s[8:11], s23 offen offset:0 nt lds
    buffer_load_dwordx4 v21, s[8:11], s23 offen offset:1024 nt lds
    buffer_load_dwordx4 v22, s[8:11], s23 offen offset:2048 nt lds
    buffer_load_dwordx4 v23, s[8:11], s23 offen offset:3072 nt lds
    s_add_u32 m0, s22, 0x1000
    s_add_u32 s23, s16, 0x2000
    s_nop 0
    buffer_load_dwordx4 v20, s[8:11], s23 offen offset:0 nt lds
    buffer_load_dwordx4 v21, s[8:11], s23 offen offset:1024 nt lds
    buffer_load_dwordx4 v22, s[8:11], s23 offen offset:2048 nt lds
    buffer_load_dwordx4 v23, s[8:11], s23 offen offset:3072 nt lds
    s_add_u32 m0, s22, 0x2000
    s_add_u32 s23, s16, 0x1000
    s_nop 0
    buffer_load_dwordx4 v20, s[8:11], s23 offen offset:0 nt lds
    buffer_load_dwordx4 v21, s[8:11], s23 offen offset:1024 nt lds
    s_add_u32 s20, s20, 1
    buffer_load_dwordx4 v22, s[8:11], s23 offen offset:2048 nt lds
    buffer_load_dwordx4 v23, s[8:11], s23 offen offset:3072 nt lds
    s_add_u32 m0, s22, 0x3000
    s_add_u32 s23, s16, 0x3000
    s_nop 0
    buffer_load_dwordx4 v20, s[8:11], s23 offen offset:0 nt lds
    s_add_u32 s22, s22, 0x4000
    s_cmp_eq_u32 s22, 0x24000
    s_cselect_b32 s22, 0, s22
    buffer_load_dwordx4 v21, s[8:11], s23 offen offset:1024 nt lds
    buffer_load_dwordx4 v22, s[8:11], s23 offen offset:2048 nt lds
    buffer_load_dwordx4 v23, s[8:11], s23 offen offset:3072 nt lds
    s_add_u32 m0, s22, 0x0
    s_add_u32 s23, s16, 0x4000
    s_nop 0
    buffer_load_dwordx4 v20, s[8:11], s23 offen offset:0 nt lds
    buffer_load_dwordx4 v21, s[8:11], s23 offen offset:1024 nt lds
    buffer_load_dwordx4 v22, s[8:11], s23 offen offset:2048 nt lds
    buffer_load_dwordx4 v23, s[8:11], s23 offen offset:3072 nt lds
    s_add_u32 m0, s22, 0x1000
    s_add_u32 s23, s16, 0x6000
    s_nop 0
    buffer_load_dwordx4 v20, s[8:11], s23 offen offset:0 nt lds
    buffer_load_dwordx4 v21, s[8:11], s23 offen offset:1024 nt lds
    buffer_load_dwordx4 v22, s[8:11], s23 offen offset:2048 nt lds
    buffer_load_dwordx4 v23, s[8:11], s23 offen offset:3072 nt lds
    s_add_u32 m0, s22, 0x2000
    s_add_u32 s23, s16, 0x5000
    s_nop 0
    buffer_load_dwordx4 v20, s[8:11], s23 offen offset:0 nt lds
    buffer_load_dwordx4 v21, s[8:11], s23 offen offset:1024 nt lds
    s_add_u32 s20, s20, 1
    buffer_load_dwordx4 v22, s[8:11], s23 offen offset:2048 nt lds
    buffer_load_dwordx4 v23, s[8:11], s23 offen offset:3072 nt lds
    s_add_u32 m0, s22, 0x3000
    s_add_u32 s23, s16, 0x7000
    s_waitcnt vmcnt(27)
    buffer_load_dwordx4 v20, s[8:11], s23 offen offset:0 nt lds
    s_add_u32 s22, s22, 0x4000
    s_cmp_eq_u32 s22, 0x24000
    s_cselect_b32 s22, 0, s22
    s_waitcnt vmcnt(27)
    buffer_load_dwordx4 v21, s[8:11], s23 offen offset:1024 nt lds
    s_waitcnt vmcnt(27)
    buffer_load_dwordx4 v22, s[8:11], s23 offen offset:2048 nt lds
    s_waitcnt vmcnt(27)
    buffer_load_dwordx4 v23, s[8:11], s23 offen offset:3072 nt lds
    s_add_u32 m0, s22, 0x0
    s_add_u32 s23, s16, 0x10000
    s_waitcnt vmcnt(27)
    buffer_load_dwordx4 v20, s[8:11], s23 offen offset:0 nt lds
    s_waitcnt vmcnt(27)
    buffer_load_dwordx4 v21, s[8:11], s23 offen offset:1024 nt lds
    s_waitcnt vmcnt(27)
    buffer_load_dwordx4 v22, s[8:11], s23 offen offset:2048 nt lds
    s_waitcnt vmcnt(27)
    buffer_load_dwordx4 v23, s[8:11], s23 offen offset:3072 nt lds
    s_add_u32 m0, s22, 0x1000
    s_add_u32 s23, s16, 0x12000
    s_waitcnt vmcnt(27)
    buffer_load_dwordx4 v20, s[8:11], s23 offen offset:0 nt lds
    s_waitcnt vmcnt(27)
    buffer_load_dwordx4 v21, s[8:11], s23 offen offset:1024 nt lds
    s_waitcnt vmcnt(27)
    buffer_load_dwordx4 v22, s[8:11], s23 offen offset:2048 nt lds
    s_waitcnt vmcnt(27)
    buffer_load_dwordx4 v23, s[8:11], s23 offen offset:3072 nt lds
    s_add_u32 m0, s22, 0x2000
    s_add_u32 s23, s16, 0x11000
    s_waitcnt vmcnt(27)
    buffer_load_dwordx4 v20, s[8:11], s23 offen offset:0 nt lds
    s_waitcnt vmcnt(27)
    buffer_load_dwordx4 v21, s[8:11], s23 offen offset:1024 nt lds
    s_add_u32 s20, s20, 1
    s_waitcnt vmcnt(27)
    buffer_load_dwordx4 v22, s[8:11], s23 offen offset:2048 nt lds
    s_waitcnt vmcnt(27)
    buffer_load_dwordx4 v23, s[8:11], s23 offen offset:3072 nt lds
    v_mov_b32 v14, 1
    ds_write_b32 v8, v14
    s_add_u32 m0, s22, 0x3000
    s_add_u32 s23, s16, 0x13000
    s_waitcnt vmcnt(27)
    buffer_load_dwordx4 v20, s[8:11], s23 offen offset:0 nt lds
    s_add_u32 s22, s22, 0x4000
    s_cmp_eq_u32 s22, 0x24000
    s_cselect_b32 s22, 0, s22
    s_waitcnt vmcnt(27)
    buffer_load_dwordx4 v21, s[8:11], s23 offen offset:1024 nt lds
    s_waitcnt vmcnt(27)
    buffer_load_dwordx4 v22, s[8:11], s23 offen offset:2048 nt lds
    s_waitcnt vmcnt(27)
    buffer_load_dwordx4 v23, s[8:11], s23 offen offset:3072 nt lds
    s_add_u32 m0, s22, 0x0
    s_add_u32 s23, s16, 0x14000
    s_waitcnt vmcnt(27)
    buffer_load_dwordx4 v20, s[8:11], s23 offen offset:0 nt lds
    s_waitcnt vmcnt(27)
    buffer_load_dwordx4 v21, s[8:11], s23 offen offset:1024 nt lds
    s_waitcnt vmcnt(27)
    buffer_load_dwordx4 v22, s[8:11], s23 offen offset:2048 nt lds
    s_waitcnt vmcnt(27)
    buffer_load_dwordx4 v23, s[8:11], s23 offen offset:3072 nt lds
    s_add_u32 m0, s22, 0x1000
    s_add_u32 s23, s16, 0x16000
    s_waitcnt vmcnt(27)
    buffer_load_dwordx4 v20, s[8:11], s23 offen offset:0 nt lds
    s_waitcnt vmcnt(27)
    buffer_load_dwordx4 v21, s[8:11], s23 offen offset:1024 nt lds
    s_waitcnt vmcnt(27)
    buffer_load_dwordx4 v22, s[8:11], s23 offen offset:2048 nt lds
    s_waitcnt vmcnt(27)
    buffer_load_dwordx4 v23, s[8:11], s23 offen offset:3072 nt lds
    s_add_u32 m0, s22, 0x2000
    s_add_u32 s23, s16, 0x15000
    s_waitcnt vmcnt(27)
    buffer_load_dwordx4 v20, s[8:11], s23 offen offset:0 nt lds
    s_waitcnt vmcnt(27)
    buffer_load_dwordx4 v21, s[8:11], s23 offen offset:1024 nt lds
    s_add_u32 s20, s20, 1
    s_waitcnt vmcnt(27)
    buffer_load_dwordx4 v22, s[8:11], s23 offen offset:2048 nt lds
    s_waitcnt vmcnt(27)
    buffer_load_dwordx4 v23, s[8:11], s23 offen offset:3072 nt lds
    v_mov_b32 v14, 2
    ds_write_b32 v8, v14
    s_add_u32 m0, s22, 0x3000
    s_add_u32 s23, s16, 0x17000
    s_waitcnt vmcnt(27)
    buffer_load_dwordx4 v20, s[8:11], s23 offen offset:0 nt lds
    s_add_u32 s22, s22, 0x4000
    s_cmp_eq_u32 s22, 0x24000
    s_cselect_b32 s22, 0, s22
    s_waitcnt vmcnt(27)
    buffer_load_dwordx4 v21, s[8:11], s23 offen offset:1024 nt lds
    s_waitcnt vmcnt(27)
    buffer_load_dwordx4 v22, s[8:11], s23 offen offset:2048 nt lds
    s_waitcnt vmcnt(27)
    buffer_load_dwordx4 v23, s[8:11], s23 offen offset:3072 nt lds
    s_add_u32 m0, s22, 0x0
    s_add_u32 s23, s16, 0x20000
    s_waitcnt vmcnt(27)
    buffer_load_dwordx4 v20, s[8:11], s23 offen offset:0 nt lds
    s_waitcnt vmcnt(27)
    buffer_load_dwordx4 v21, s[8:11], s23 offen offset:1024 nt lds
    s_waitcnt vmcnt(27)
    buffer_load_dwordx4 v22, s[8:11], s23 offen offset:2048 nt lds
    s_waitcnt vmcnt(27)
    buffer_load_dwordx4 v23, s[8:11], s23 offen offset:3072 nt lds
    s_add_u32 m0, s22, 0x1000
    s_add_u32 s23, s16, 0x22000
    s_waitcnt vmcnt(27)
    buffer_load_dwordx4 v20, s[8:11], s23 offen offset:0 nt lds
    s_waitcnt vmcnt(27)
    buffer_load_dwordx4 v21, s[8:11], s23 offen offset:1024 nt lds
    s_waitcnt vmcnt(27)
    buffer_load_dwordx4 v22, s[8:11], s23 offen offset:2048 nt lds
    s_waitcnt vmcnt(27)
    buffer_load_dwordx4 v23, s[8:11], s23 offen offset:3072 nt lds
    s_add_u32 m0, s22, 0x2000
    s_add_u32 s23, s16, 0x21000
    s_waitcnt vmcnt(27)
    buffer_load_dwordx4 v20, s[8:11], s23 offen offset:0 nt lds
    s_waitcnt vmcnt(27)
    buffer_load_dwordx4 v21, s[8:11], s23 offen offset:1024 nt lds
    s_add_u32 s20, s20, 1
    s_waitcnt vmcnt(27)
    buffer_load_dwordx4 v22, s[8:11], s23 offen offset:2048 nt lds
    s_waitcnt vmcnt(27)
    buffer_load_dwordx4 v23, s[8:11], s23 offen offset:3072 nt lds
    v_mov_b32 v14, 3
    ds_write_b32 v8, v14
    s_add_u32 m0, s22, 0x3000
    s_add_u32 s23, s16, 0x23000
    s_waitcnt vmcnt(27)
    buffer_load_dwordx4 v20, s[8:11], s23 offen offset:0 nt lds
    s_add_u32 s22, s22, 0x4000
    s_cmp_eq_u32 s22, 0x24000
    s_cselect_b32 s22, 0, s22
    s_waitcnt vmcnt(27)
    buffer_load_dwordx4 v21, s[8:11], s23 offen offset:1024 nt lds
    s_waitcnt vmcnt(27)
    buffer_load_dwordx4 v22, s[8:11], s23 offen offset:2048 nt lds
    s_waitcnt vmcnt(27)
    buffer_load_dwordx4 v23, s[8:11], s23 offen offset:3072 nt lds
    s_add_u32 m0, s22, 0x0
    s_add_u32 s23, s16, 0x24000
    s_waitcnt vmcnt(27)
    buffer_load_dwordx4 v20, s[8:11], s23 offen offset:0 nt lds
    s_waitcnt vmcnt(27)
    buffer_load_dwordx4 v21, s[8:11], s23 offen offset:1024 nt lds
    s_waitcnt vmcnt(27)
    buffer_load_dwordx4 v22, s[8:11], s23 offen offset:2048 nt lds
    s_waitcnt vmcnt(27)
    buffer_load_dwordx4 v23, s[8:11], s23 offen offset:3072 nt lds
    s_add_u32 m0, s22, 0x1000
    s_add_u32 s23, s16, 0x26000
    s_waitcnt vmcnt(27)
    buffer_load_dwordx4 v20, s[8:11], s23 offen offset:0 nt lds
    s_waitcnt vmcnt(27)
    buffer_load_dwordx4 v21, s[8:11], s23 offen offset:1024 nt lds
    s_waitcnt vmcnt(27)
    buffer_load_dwordx4 v22, s[8:11], s23 offen offset:2048 nt lds
    s_waitcnt vmcnt(27)
    buffer_load_dwordx4 v23, s[8:11], s23 offen offset:3072 nt lds
    s_add_u32 m0, s22, 0x2000
    s_add_u32 s23, s16, 0x25000
    s_waitcnt vmcnt(27)
    buffer_load_dwordx4 v20, s[8:11], s23 offen offset:0 nt lds
    s_waitcnt vmcnt(27)
    buffer_load_dwordx4 v21, s[8:11], s23 offen offset:1024 nt lds
    s_add_u32 s20, s20, 1
    s_waitcnt vmcnt(27)
    buffer_load_dwordx4 v22, s[8:11], s23 offen offset:2048 nt lds
    s_waitcnt vmcnt(27)
    buffer_load_dwordx4 v23, s[8:11], s23 offen offset:3072 nt lds
    v_mov_b32 v14, 4
    ds_write_b32 v8, v14
    s_add_u32 m0, s22, 0x3000
    s_add_u32 s23, s16, 0x27000
    s_waitcnt vmcnt(27)
    buffer_load_dwordx4 v20, s[8:11], s23 offen offset:0 nt lds
    s_add_u32 s22, s22, 0x4000
    s_cmp_eq_u32 s22, 0x24000
    s_cselect_b32 s22, 0, s22
    s_waitcnt vmcnt(27)
    buffer_load_dwordx4 v21, s[8:11], s23 offen offset:1024 nt lds
    s_waitcnt vmcnt(27)
    buffer_load_dwordx4 v22, s[8:11], s23 offen offset:2048 nt lds
    s_waitcnt vmcnt(27)
    buffer_load_dwordx4 v23, s[8:11], s23 offen offset:3072 nt lds
    s_add_u32 m0, s22, 0x0
    s_add_u32 s23, s16, 0x30000
    s_waitcnt vmcnt(27)
    buffer_load_dwordx4 v20, s[8:11], s23 offen offset:0 nt lds
    s_waitcnt vmcnt(27)
    buffer_load_dwordx4 v21, s[8:11], s23 offen offset:1024 nt lds
    s_waitcnt vmcnt(27)
    buffer_load_dwordx4 v22, s[8:11], s23 offen offset:2048 nt lds
    s_waitcnt vmcnt(27)
    buffer_load_dwordx4 v23, s[8:11], s23 offen offset:3072 nt lds
    s_add_u32 m0, s22, 0x1000
    s_add_u32 s23, s16, 0x32000
    s_waitcnt vmcnt(27)
    buffer_load_dwordx4 v20, s[8:11], s23 offen offset:0 nt lds
    s_waitcnt vmcnt(27)
    buffer_load_dwordx4 v21, s[8:11], s23 offen offset:1024 nt lds
    s_waitcnt vmcnt(27)
    buffer_load_dwordx4 v22, s[8:11], s23 offen offset:2048 nt lds
    s_waitcnt vmcnt(27)
    buffer_load_dwordx4 v23, s[8:11], s23 offen offset:3072 nt lds
    s_add_u32 m0, s22, 0x2000
    s_add_u32 s23, s16, 0x31000
    s_waitcnt vmcnt(27)
    buffer_load_dwordx4 v20, s[8:11], s23 offen offset:0 nt lds
    s_waitcnt vmcnt(27)
    buffer_load_dwordx4 v21, s[8:11], s23 offen offset:1024 nt lds
    ds_read_b32 v15, v7
    s_add_u32 s20, s20, 1
    s_waitcnt vmcnt(27)
    buffer_load_dwordx4 v22, s[8:11], s23 offen offset:2048 nt lds
    s_waitcnt vmcnt(27)
    buffer_load_dwordx4 v23, s[8:11], s23 offen offset:3072 nt lds
    v_mov_b32 v14, 5
    ds_write_b32 v8, v14
    s_add_u32 m0, s22, 0x3000
    s_add_u32 s23, s16, 0x33000
    s_waitcnt vmcnt(27)
    buffer_load_dwordx4 v20, s[8:11], s23 offen offset:0 nt lds
    s_add_u32 s22, s22, 0x4000
    s_cmp_eq_u32 s22, 0x24000
    s_cselect_b32 s22, 0, s22
    s_waitcnt vmcnt(27)
    buffer_load_dwordx4 v21, s[8:11], s23 offen offset:1024 nt lds
    s_waitcnt vmcnt(27)
    buffer_load_dwordx4 v22, s[8:11], s23 offen offset:2048 nt lds
    s_waitcnt lgkmcnt(0)
    v_readfirstlane_b32 s19, v15
    s_and_b32 s24, s19, 0xffff
    s_waitcnt vmcnt(27)
    buffer_load_dwordx4 v23, s[8:11], s23 offen offset:3072 nt lds
    s_cmp_lt_i32 s24, 1
    s_cbranch_scc1 .Lspinf
.Lgof:
    s_add_u32 m0, s22, 0x0
    s_add_u32 s23, s16, 0x34000
    s_waitcnt vmcnt(23)
    buffer_load_dwordx4 v20, s[8:11], s23 offen offset:0 nt lds
    s_waitcnt vmcnt(23)
    buffer_load_dwordx4 v21, s[8:11], s23 offen offset:1024 nt lds
    s_waitcnt vmcnt(23)
    buffer_load_dwordx4 v22, s[8:11], s23 offen offset:2048 nt lds
    s_waitcnt vmcnt(23)
    buffer_load_dwordx4 v23, s[8:11], s23 offen offset:3072 nt lds
    s_add_u32 m0, s22, 0x1000
    s_add_u32 s23, s16, 0x36000
    s_waitcnt vmcnt(23)
    buffer_load_dwordx4 v20, s[8:11], s23 offen offset:0 nt lds
    s_waitcnt vmcnt(23)
    buffer_load_dwordx4 v21, s[8:11], s23 offen offset:1024 nt lds
    s_waitcnt vmcnt(23)
    buffer_load_dwordx4 v22, s[8:11], s23 offen offset:2048 nt lds
    s_waitcnt vmcnt(23)
    buffer_load_dwordx4 v23, s[8:11], s23 offen offset:3072 nt lds
    v_mov_b32 v14, 6
    ds_write_b32 v8, v14
    s_add_u32 m0, s22, 0x2000
    s_add_u32 s23, s16, 0x35000
    s_waitcnt vmcnt(23)
    buffer_load_dwordx4 v20, s[8:11], s23 offen offset:0 nt lds
    s_waitcnt vmcnt(23)
    buffer_load_dwordx4 v21, s[8:11], s23 offen offset:1024 nt lds
    ds_read_b32 v15, v7
    s_add_u32 s20, s20, 1
    s_waitcnt vmcnt(23)
    buffer_load_dwordx4 v22, s[8:11], s23 offen offset:2048 nt lds
    s_waitcnt vmcnt(23)
    buffer_load_dwordx4 v23, s[8:11], s23 offen offset:3072 nt lds
    s_add_u32 m0, s22, 0x3000
    s_add_u32 s23, s16, 0x37000
    s_waitcnt vmcnt(23)
    buffer_load_dwordx4 v20, s[8:11], s23 offen offset:0 nt lds
    s_add_u32 s22, s22, 0x4000
    s_cmp_eq_u32 s22, 0x24000
    s_cselect_b32 s22, 0, s22
    s_waitcnt vmcnt(23)
    buffer_load_dwordx4 v21, s[8:11], s23 offen offset:1024 nt lds
    s_add_u32 s16, s16, 0x40000
    s_cmp_eq_u32 s20, 57
    s_cselect_b32 s16, s27, s16
    s_waitcnt vmcnt(23)
    buffer_load_dwordx4 v22, s[8:11], s23 offen offset:2048 nt lds
    s_waitcnt lgkmcnt(0)
    v_readfirstlane_b32 s19, v15
    s_and_b32 s24, s19, 0xffff
    s_waitcnt vmcnt(23)
    buffer_load_dwordx4 v23, s[8:11], s23 offen offset:3072 nt lds
    s_branch .Lload2
.p2align 6
.Lload0:
    s_cmp_lt_i32 s24, s20
    s_cbranch_scc1 .Lspinm0_0
.Lgom0_0:
    s_add_u32 m0, s22, 0x0
    s_add_u32 s23, s16, 0x0
    s_waitcnt vmcnt(17)
    buffer_load_dwordx4 v20, s[8:11], s23 offen offset:0 nt lds
    s_waitcnt vmcnt(17)
    buffer_load_dwordx4 v21, s[8:11], s23 offen offset:1024 nt lds
    s_add_u32 s21, s20, 6
    v_mov_b32 v14, s21
    ds_write_b32 v8, v14
    s_waitcnt vmcnt(17)
    buffer_load_dwordx4 v22, s[8:11], s23 offen offset:2048 nt lds
    s_waitcnt vmcnt(17)
    buffer_load_dwordx4 v23, s[8:11], s23 offen offset:3072 nt lds
    s_add_u32 m0, s22, 0x1000
    s_add_u32 s23, s16, 0x2000
    s_waitcnt vmcnt(17)
    buffer_load_dwordx4 v20, s[8:11], s23 offen offset:0 nt lds
    s_waitcnt vmcnt(17)
    buffer_load_dwordx4 v21, s[8:11], s23 offen offset:1024 nt lds
    s_waitcnt vmcnt(17)
    buffer_load_dwordx4 v22, s[8:11], s23 offen offset:2048 nt lds
    s_waitcnt vmcnt(17)
    buffer_load_dwordx4 v23, s[8:11], s23 offen offset:3072 nt lds
    s_add_u32 m0, s22, 0x2000
    s_add_u32 s23, s16, 0x1000
    s_waitcnt vmcnt(17)
    buffer_load_dwordx4 v20, s[8:11], s23 offen offset:0 nt lds
    s_waitcnt vmcnt(17)
    buffer_load_dwordx4 v21, s[8:11], s23 offen offset:1024 nt lds
    ds_read_b32 v15, v7
    s_add_u32 s20, s20, 1
    s_waitcnt vmcnt(17)
    buffer_load_dwordx4 v22, s[8:11], s23 offen offset:2048 nt lds
    s_waitcnt vmcnt(17)
    buffer_load_dwordx4 v23, s[8:11], s23 offen offset:3072 nt lds
    s_add_u32 m0, s22, 0x3000
    s_add_u32 s23, s16, 0x3000
    s_waitcnt vmcnt(17)
    buffer_load_dwordx4 v20, s[8:11], s23 offen offset:0 nt lds
    s_add_u32 s22, s22, 0x4000
    s_cmp_eq_u32 s22, 0x24000
    s_cselect_b32 s22, 0, s22
    s_waitcnt vmcnt(17)
    buffer_load_dwordx4 v21, s[8:11], s23 offen offset:1024 nt lds
    s_waitcnt vmcnt(17)
    buffer_load_dwordx4 v22, s[8:11], s23 offen offset:2048 nt lds
    s_waitcnt lgkmcnt(0)
    v_readfirstlane_b32 s19, v15
    s_and_b32 s24, s19, 0xffff
    s_waitcnt vmcnt(17)
    buffer_load_dwordx4 v23, s[8:11], s23 offen offset:3072 nt lds
    s_cmp_lt_i32 s24, s20
    s_cbranch_scc1 .Lspinm0_1
.Lgom0_1:
    s_add_u32 m0, s22, 0x0
    s_add_u32 s23, s16, 0x4000
    s_waitcnt vmcnt(17)
    buffer_load_dwordx4 v20, s[8:11], s23 offen offset:0 nt lds
    s_waitcnt vmcnt(17)
    buffer_load_dwordx4 v21, s[8:11], s23 offen offset:1024 nt lds
    s_add_u32 s21, s20, 6
    v_mov_b32 v14, s21
    ds_write_b32 v8, v14
    s_waitcnt vmcnt(17)
    buffer_load_dwordx4 v22, s[8:11], s23 offen offset:2048 nt lds
    s_waitcnt vmcnt(17)
    buffer_load_dwordx4 v23, s[8:11], s23 offen offset:3072 nt lds
    s_add_u32 m0, s22, 0x1000
    s_add_u32 s23, s16, 0x6000
    s_waitcnt vmcnt(17)
    buffer_load_dwordx4 v20, s[8:11], s23 offen offset:0 nt lds
    s_waitcnt vmcnt(17)
    buffer_load_dwordx4 v21, s[8:11], s23 offen offset:1024 nt lds
    s_waitcnt vmcnt(17)
    buffer_load_dwordx4 v22, s[8:11], s23 offen offset:2048 nt lds
    s_waitcnt vmcnt(17)
    buffer_load_dwordx4 v23, s[8:11], s23 offen offset:3072 nt lds
    s_add_u32 m0, s22, 0x2000
    s_add_u32 s23, s16, 0x5000
    s_waitcnt vmcnt(17)
    buffer_load_dwordx4 v20, s[8:11], s23 offen offset:0 nt lds
    s_waitcnt vmcnt(17)
    buffer_load_dwordx4 v21, s[8:11], s23 offen offset:1024 nt lds
    ds_read_b32 v15, v7
    s_add_u32 s20, s20, 1
    s_waitcnt vmcnt(17)
    buffer_load_dwordx4 v22, s[8:11], s23 offen offset:2048 nt lds
    s_waitcnt vmcnt(17)
    buffer_load_dwordx4 v23, s[8:11], s23 offen offset:3072 nt lds
    s_add_u32 m0, s22, 0x3000
    s_add_u32 s23, s16, 0x7000
    s_waitcnt vmcnt(17)
    buffer_load_dwordx4 v20, s[8:11], s23 offen offset:0 nt lds
    s_add_u32 s22, s22, 0x4000
    s_cmp_eq_u32 s22, 0x24000
    s_cselect_b32 s22, 0, s22
    s_waitcnt vmcnt(17)
    buffer_load_dwordx4 v21, s[8:11], s23 offen offset:1024 nt lds
    s_add_u32 s16, s16, 0x10000
    s_cmp_eq_u32 s20, 57
    s_cselect_b32 s16, s27, s16
    s_waitcnt vmcnt(17)
    buffer_load_dwordx4 v22, s[8:11], s23 offen offset:2048 nt lds
    s_waitcnt lgkmcnt(0)
    v_readfirstlane_b32 s19, v15
    s_and_b32 s24, s19, 0xffff
    s_waitcnt vmcnt(17)
    buffer_load_dwordx4 v23, s[8:11], s23 offen offset:3072 nt lds
    s_cmp_ge_i32 s20, s26
    s_cbranch_scc1 .Lturn
    s_cmp_lt_u32 s19, 0x10000
    s_cbranch_scc1 .Lload0
    s_cmp_lt_u32 s19, 0x20000
    s_cbranch_scc1 .Lload1
    s_cmp_lt_u32 s19, 0x30000
    s_cbranch_scc1 .Lload2
    s_cmp_lt_u32 s19, 0x40000
    s_cbranch_scc1 .Lload3
    s_cmp_lt_u32 s19, 0x50000
    s_cbranch_scc1 .Lload4
    s_branch .Lload5
.p2align 6
.Lload1:
    s_cmp_lt_i32 s24, s20
    s_cbranch_scc1 .Lspinm1_0
.Lgom1_0:
    s_add_u32 m0, s22, 0x0
    s_add_u32 s23, s16, 0x0
    s_waitcnt vmcnt(18)
    buffer_load_dwordx4 v20, s[8:11], s23 offen offset:0 nt lds
    s_waitcnt vmcnt(18)
    buffer_load_dwordx4 v21, s[8:11], s23 offen offset:1024 nt lds
    s_waitcnt vmcnt(18)
    buffer_load_dwordx4 v22, s[8:11], s23 offen offset:2048 nt lds
    s_add_u32 s21, s20, 6
    v_mov_b32 v14, s21
    ds_write_b32 v8, v14
    s_waitcnt vmcnt(18)
    buffer_load_dwordx4 v23, s[8:11], s23 offen offset:3072 nt lds
    s_add_u32 m0, s22, 0x1000
    s_add_u32 s23, s16, 0x2000
    s_waitcnt vmcnt(18)
    buffer_load_dwordx4 v20, s[8:11], s23 offen offset:0 nt lds
    s_waitcnt vmcnt(18)
    buffer_load_dwordx4 v21, s[8:11], s23 offen offset:1024 nt lds
    s_waitcnt vmcnt(18)
    buffer_load_dwordx4 v22, s[8:11], s23 offen offset:2048 nt lds
    s_waitcnt vmcnt(18)
    buffer_load_dwordx4 v23, s[8:11], s23 offen offset:3072 nt lds
    s_add_u32 m0, s22, 0x2000
    s_add_u32 s23, s16, 0x1000
    s_waitcnt vmcnt(18)
    buffer_load_dwordx4 v20, s[8:11], s23 offen offset:0 nt lds
    s_waitcnt vmcnt(18)
    buffer_load_dwordx4 v21, s[8:11], s23 offen offset:1024 nt lds
    ds_read_b32 v15, v7
    s_add_u32 s20, s20, 1
    s_waitcnt vmcnt(18)
    buffer_load_dwordx4 v22, s[8:11], s23 offen offset:2048 nt lds
    s_waitcnt vmcnt(18)
    buffer_load_dwordx4 v23, s[8:11], s23 offen offset:3072 nt lds
    s_add_u32 m0, s22, 0x3000
    s_add_u32 s23, s16, 0x3000
    s_waitcnt vmcnt(18)
    buffer_load_dwordx4 v20, s[8:11], s23 offen offset:0 nt lds
    s_add_u32 s22, s22, 0x4000
    s_cmp_eq_u32 s22, 0x24000
    s_cselect_b32 s22, 0, s22
    s_waitcnt vmcnt(18)
    buffer_load_dwordx4 v21, s[8:11], s23 offen offset:1024 nt lds
    s_waitcnt vmcnt(18)
    buffer_load_dwordx4 v22, s[8:11], s23 offen offset:2048 nt lds
    s_waitcnt lgkmcnt(0)
    v_readfirstlane_b32 s19, v15
    s_and_b32 s24, s19, 0xffff
    s_waitcnt vmcnt(18)
    buffer_load_dwordx4 v23, s[8:11], s23 offen offset:3072 nt lds
    s_cmp_lt_i32 s24, s20
    s_cbranch_scc1 .Lspinm1_1
.Lgom1_1:
    s_add_u32 m0, s22, 0x0
    s_add_u32 s23, s16, 0x4000
    s_waitcnt vmcnt(18)
    buffer_load_dwordx4 v20, s[8:11], s23 offen offset:0 nt lds
    s_waitcnt vmcnt(18)
    buffer_load_dwordx4 v21, s[8:11], s23 offen offset:1024 nt lds
    s_waitcnt vmcnt(18)
    buffer_load_dwordx4 v22, s[8:11], s23 offen offset:2048 nt lds
    s_add_u32 s21, s20, 6
    v_mov_b32 v14, s21
    ds_write_b32 v8, v14
    s_waitcnt vmcnt(18)
    buffer_load_dwordx4 v23, s[8:11], s23 offen offset:3072 nt lds
    s_add_u32 m0, s22, 0x1000
    s_add_u32 s23, s16, 0x6000
    s_waitcnt vmcnt(18)
    buffer_load_dwordx4 v20, s[8:11], s23 offen offset:0 nt lds
    s_waitcnt vmcnt(18)
    buffer_load_dwordx4 v21, s[8:11], s23 offen offset:1024 nt lds
    s_waitcnt vmcnt(18)
    buffer_load_dwordx4 v22, s[8:11], s23 offen offset:2048 nt lds
    s_waitcnt vmcnt(18)
    buffer_load_dwordx4 v23, s[8:11], s23 offen offset:3072 nt lds
    s_add_u32 m0, s22, 0x2000
    s_add_u32 s23, s16, 0x5000
    s_waitcnt vmcnt(18)
    buffer_load_dwordx4 v20, s[8:11], s23 offen offset:0 nt lds
    s_waitcnt vmcnt(18)
    buffer_load_dwordx4 v21, s[8:11], s23 offen offset:1024 nt lds
    ds_read_b32 v15, v7
    s_add_u32 s20, s20, 1
    s_waitcnt vmcnt(18)
    buffer_load_dwordx4 v22, s[8:11], s23 offen offset:2048 nt lds
    s_waitcnt vmcnt(18)
    buffer_load_dwordx4 v23, s[8:11], s23 offen offset:3072 nt lds
    s_add_u32 m0, s22, 0x3000
    s_add_u32 s23, s16, 0x7000
    s_waitcnt vmcnt(18)
    buffer_load_dwordx4 v20, s[8:11], s23 offen offset:0 nt lds
    s_add_u32 s22, s22, 0x4000
    s_cmp_eq_u32 s22, 0x24000
    s_cselect_b32 s22, 0, s22
    s_waitcnt vmcnt(18)
    buffer_load_dwordx4 v21, s[8:11], s23 offen offset:1024 nt lds
    s_add_u32 s16, s16, 0x10000
    s_cmp_eq_u32 s20, 57
    s_cselect_b32 s16, s27, s16
    s_waitcnt vmcnt(18)
    buffer_load_dwordx4 v22, s[8:11], s23 offen offset:2048 nt lds
    s_waitcnt lgkmcnt(0)
    v_readfirstlane_b32 s19, v15
    s_and_b32 s24, s19, 0xffff
    s_waitcnt vmcnt(18)
    buffer_load_dwordx4 v23, s[8:11], s23 offen offset:3072 nt lds
    s_cmp_ge_i32 s20, s26
    s_cbranch_scc1 .Lturn
    s_cmp_lt_u32 s19, 0x10000
    s_cbranch_scc1 .Lload0
    s_cmp_lt_u32 s19, 0x20000
    s_cbranch_scc1 .Lload1
    s_cmp_lt_u32 s19, 0x30000
    s_cbranch_scc1 .Lload2
    s_cmp_lt_u32 s19, 0x40000
    s_cbranch_scc1 .Lload3
    s_cmp_lt_u32 s19, 0x50000
    s_cbranch_scc1 .Lload4
    s_branch .Lload5
.p2align 6
.Lload2:
    s_cmp_lt_i32 s24, s20
    s_cbranch_scc1 .Lspinm2_0
.Lgom2_0:
    s_add_u32 m0, s22, 0x0
    s_add_u32 s23, s16, 0x0
    s_waitcnt vmcnt(19)
    buffer_load_dwordx4 v20, s[8:11], s23 offen offset:0 nt lds
    s_waitcnt vmcnt(19)
    buffer_load_dwordx4 v21, s[8:11], s23 offen offset:1024 nt lds
    s_waitcnt vmcnt(19)
    buffer_load_dwordx4 v22, s[8:11], s23 offen offset:2048 nt lds
    s_waitcnt vmcnt(19)
    buffer_load_dwordx4 v23, s[8:11], s23 offen offset:3072 nt lds
    s_add_u32 s21, s20, 6
    v_mov_b32 v14, s21
    ds_write_b32 v8, v14
    s_add_u32 m0, s22, 0x1000
    s_add_u32 s23, s16, 0x2000
    s_waitcnt vmcnt(19)
    buffer_load_dwordx4 v20, s[8:11], s23 offen offset:0 nt lds
    s_waitcnt vmcnt(19)
    buffer_load_dwordx4 v21, s[8:11], s23 offen offset:1024 nt lds
    s_waitcnt vmcnt(19)
    buffer_load_dwordx4 v22, s[8:11], s23 offen offset:2048 nt lds
    s_waitcnt vmcnt(19)
    buffer_load_dwordx4 v23, s[8:11], s23 offen offset:3072 nt lds
    s_add_u32 m0, s22, 0x2000
    s_add_u32 s23, s16, 0x1000
    s_waitcnt vmcnt(19)
    buffer_load_dwordx4 v20, s[8:11], s23 offen offset:0 nt lds
    s_waitcnt vmcnt(19)
    buffer_load_dwordx4 v21, s[8:11], s23 offen offset:1024 nt lds
    ds_read_b32 v15, v7
    s_add_u32 s20, s20, 1
    s_waitcnt vmcnt(19)
    buffer_load_dwordx4 v22, s[8:11], s23 offen offset:2048 nt lds
    s_waitcnt vmcnt(19)
    buffer_load_dwordx4 v23, s[8:11], s23 offen offset:3072 nt lds
    s_add_u32 m0, s22, 0x3000
    s_add_u32 s23, s16, 0x3000
    s_waitcnt vmcnt(19)
    buffer_load_dwordx4 v20, s[8:11], s23 offen offset:0 nt lds
    s_add_u32 s22, s22, 0x4000
    s_cmp_eq_u32 s22, 0x24000
    s_cselect_b32 s22, 0, s22
    s_waitcnt vmcnt(19)
    buffer_load_dwordx4 v21, s[8:11], s23 offen offset:1024 nt lds
    s_waitcnt vmcnt(19)
    buffer_load_dwordx4 v22, s[8:11], s23 offen offset:2048 nt lds
    s_waitcnt lgkmcnt(0)
    v_readfirstlane_b32 s19, v15
    s_and_b32 s24, s19, 0xffff
    s_waitcnt vmcnt(19)
    buffer_load_dwordx4 v23, s[8:11], s23 offen offset:3072 nt lds
    s_cmp_lt_i32 s24, s20
    s_cbranch_scc1 .Lspinm2_1
.Lgom2_1:
    s_add_u32 m0, s22, 0x0
    s_add_u32 s23, s16, 0x4000
    s_waitcnt vmcnt(19)
    buffer_load_dwordx4 v20, s[8:11], s23 offen offset:0 nt lds
    s_waitcnt vmcnt(19)
    buffer_load_dwordx4 v21, s[8:11], s23 offen offset:1024 nt lds
    s_waitcnt vmcnt(19)
    buffer_load_dwordx4 v22, s[8:11], s23 offen offset:2048 nt lds
    s_waitcnt vmcnt(19)
    buffer_load_dwordx4 v23, s[8:11], s23 offen offset:3072 nt lds
    s_add_u32 s21, s20, 6
    v_mov_b32 v14, s21
    ds_write_b32 v8, v14
    s_add_u32 m0, s22, 0x1000
    s_add_u32 s23, s16, 0x6000
    s_waitcnt vmcnt(19)
    buffer_load_dwordx4 v20, s[8:11], s23 offen offset:0 nt lds
    s_waitcnt vmcnt(19)
    buffer_load_dwordx4 v21, s[8:11], s23 offen offset:1024 nt lds
    s_waitcnt vmcnt(19)
    buffer_load_dwordx4 v22, s[8:11], s23 offen offset:2048 nt lds
    s_waitcnt vmcnt(19)
    buffer_load_dwordx4 v23, s[8:11], s23 offen offset:3072 nt lds
    s_add_u32 m0, s22, 0x2000
    s_add_u32 s23, s16, 0x5000
    s_waitcnt vmcnt(19)
    buffer_load_dwordx4 v20, s[8:11], s23 offen offset:0 nt lds
    s_waitcnt vmcnt(19)
    buffer_load_dwordx4 v21, s[8:11], s23 offen offset:1024 nt lds
    ds_read_b32 v15, v7
    s_add_u32 s20, s20, 1
    s_waitcnt vmcnt(19)
    buffer_load_dwordx4 v22, s[8:11], s23 offen offset:2048 nt lds
    s_waitcnt vmcnt(19)
    buffer_load_dwordx4 v23, s[8:11], s23 offen offset:3072 nt lds
    s_add_u32 m0, s22, 0x3000
    s_add_u32 s23, s16, 0x7000
    s_waitcnt vmcnt(19)
    buffer_load_dwordx4 v20, s[8:11], s23 offen offset:0 nt lds
    s_add_u32 s22, s22, 0x4000
    s_cmp_eq_u32 s22, 0x24000
    s_cselect_b32 s22, 0, s22
    s_waitcnt vmcnt(19)
    buffer_load_dwordx4 v21, s[8:11], s23 offen offset:1024 nt lds
    s_add_u32 s16, s16, 0x10000
    s_cmp_eq_u32 s20, 57
    s_cselect_b32 s16, s27, s16
    s_waitcnt vmcnt(19)
    buffer_load_dwordx4 v22, s[8:11], s23 offen offset:2048 nt lds
    s_waitcnt lgkmcnt(0)
    v_readfirstlane_b32 s19, v15
    s_and_b32 s24, s19, 0xffff
    s_waitcnt vmcnt(19)
    buffer_load_dwordx4 v23, s[8:11], s23 offen offset:3072 nt lds
    s_cmp_ge_i32 s20, s26
    s_cbranch_scc1 .Lturn
    s_cmp_lt_u32 s19, 0x10000
    s_cbranch_scc1 .Lload0
    s_cmp_lt_u32 s19, 0x20000
    s_cbranch_scc1 .Lload1
    s_cmp_lt_u32 s19, 0x30000
    s_cbranch_scc1 .Lload2
    s_cmp_lt_u32 s19, 0x40000
    s_cbranch_scc1 .Lload3
    s_cmp_lt_u32 s19, 0x50000
    s_cbranch_scc1 .Lload4
    s_branch .Lload5
.p2align 6
.Lload3:
    s_cmp_lt_i32 s24, s20
    s_cbranch_scc1 .Lspinm3_0
.Lgom3_0:
    s_add_u32 m0, s22, 0x0
    s_add_u32 s23, s16, 0x0
    s_waitcnt vmcnt(20)
    buffer_load_dwordx4 v20, s[8:11], s23 offen offset:0 nt lds
    s_waitcnt vmcnt(20)
    buffer_load_dwordx4 v21, s[8:11], s23 offen offset:1024 nt lds
    s_waitcnt vmcnt(20)
    buffer_load_dwordx4 v22, s[8:11], s23 offen offset:2048 nt lds
    s_waitcnt vmcnt(20)
    buffer_load_dwordx4 v23, s[8:11], s23 offen offset:3072 nt lds
    s_add_u32 m0, s22, 0x1000
    s_add_u32 s23, s16, 0x2000
    s_waitcnt vmcnt(20)
    buffer_load_dwordx4 v20, s[8:11], s23 offen offset:0 nt lds
    s_add_u32 s21, s20, 6
    v_mov_b32 v14, s21
    ds_write_b32 v8, v14
    s_waitcnt vmcnt(20)
    buffer_load_dwordx4 v21, s[8:11], s23 offen offset:1024 nt lds
    s_waitcnt vmcnt(20)
    buffer_load_dwordx4 v22, s[8:11], s23 offen offset:2048 nt lds
    s_waitcnt vmcnt(20)
    buffer_load_dwordx4 v23, s[8:11], s23 offen offset:3072 nt lds
    s_add_u32 m0, s22, 0x2000
    s_add_u32 s23, s16, 0x1000
    s_waitcnt vmcnt(20)
    buffer_load_dwordx4 v20, s[8:11], s23 offen offset:0 nt lds
    s_waitcnt vmcnt(20)
    buffer_load_dwordx4 v21, s[8:11], s23 offen offset:1024 nt lds
    ds_read_b32 v15, v7
    s_add_u32 s20, s20, 1
    s_waitcnt vmcnt(20)
    buffer_load_dwordx4 v22, s[8:11], s23 offen offset:2048 nt lds
    s_waitcnt vmcnt(20)
    buffer_load_dwordx4 v23, s[8:11], s23 offen offset:3072 nt lds
    s_add_u32 m0, s22, 0x3000
    s_add_u32 s23, s16, 0x3000
    s_waitcnt vmcnt(20)
    buffer_load_dwordx4 v20, s[8:11], s23 offen offset:0 nt lds
    s_add_u32 s22, s22, 0x4000
    s_cmp_eq_u32 s22, 0x24000
    s_cselect_b32 s22, 0, s22
    s_waitcnt vmcnt(20)
    buffer_load_dwordx4 v21, s[8:11], s23 offen offset:1024 nt lds
    s_waitcnt vmcnt(20)
    buffer_load_dwordx4 v22, s[8:11], s23 offen offset:2048 nt lds
    s_waitcnt lgkmcnt(0)
    v_readfirstlane_b32 s19, v15
    s_and_b32 s24, s19, 0xffff
    s_waitcnt vmcnt(20)
    buffer_load_dwordx4 v23, s[8:11], s23 offen offset:3072 nt lds
    s_cmp_lt_i32 s24, s20
    s_cbranch_scc1 .Lspinm3_1
.Lgom3_1:
    s_add_u32 m0, s22, 0x0
    s_add_u32 s23, s16, 0x4000
    s_waitcnt vmcnt(20)
    buffer_load_dwordx4 v20, s[8:11], s23 offen offset:0 nt lds
    s_waitcnt vmcnt(20)
    buffer_load_dwordx4 v21, s[8:11], s23 offen offset:1024 nt lds
    s_waitcnt vmcnt(20)
    buffer_load_dwordx4 v22, s[8:11], s23 offen offset:2048 nt lds
    s_waitcnt vmcnt(20)
    buffer_load_dwordx4 v23, s[8:11], s23 offen offset:3072 nt lds
    s_add_u32 m0, s22, 0x1000
    s_add_u32 s23, s16, 0x6000
    s_waitcnt vmcnt(20)
    buffer_load_dwordx4 v20, s[8:11], s23 offen offset:0 nt lds
    s_add_u32 s21, s20, 6
    v_mov_b32 v14, s21
    ds_write_b32 v8, v14
    s_waitcnt vmcnt(20)
    buffer_load_dwordx4 v21, s[8:11], s23 offen offset:1024 nt lds
    s_waitcnt vmcnt(20)
    buffer_load_dwordx4 v22, s[8:11], s23 offen offset:2048 nt lds
    s_waitcnt vmcnt(20)
    buffer_load_dwordx4 v23, s[8:11], s23 offen offset:3072 nt lds
    s_add_u32 m0, s22, 0x2000
    s_add_u32 s23, s16, 0x5000
    s_waitcnt vmcnt(20)
    buffer_load_dwordx4 v20, s[8:11], s23 offen offset:0 nt lds
    s_waitcnt vmcnt(20)
    buffer_load_dwordx4 v21, s[8:11], s23 offen offset:1024 nt lds
    ds_read_b32 v15, v7
    s_add_u32 s20, s20, 1
    s_waitcnt vmcnt(20)
    buffer_load_dwordx4 v22, s[8:11], s23 offen offset:2048 nt lds
    s_waitcnt vmcnt(20)
    buffer_load_dwordx4 v23, s[8:11], s23 offen offset:3072 nt lds
    s_add_u32 m0, s22, 0x3000
    s_add_u32 s23, s16, 0x7000
    s_waitcnt vmcnt(20)
    buffer_load_dwordx4 v20, s[8:11], s23 offen offset:0 nt lds
    s_add_u32 s22, s22, 0x4000
    s_cmp_eq_u32 s22, 0x24000
    s_cselect_b32 s22, 0, s22
    s_waitcnt vmcnt(20)
    buffer_load_dwordx4 v21, s[8:11], s23 offen offset:1024 nt lds
    s_add_u32 s16, s16, 0x10000
    s_cmp_eq_u32 s20, 57
    s_cselect_b32 s16, s27, s16
    s_waitcnt vmcnt(20)
    buffer_load_dwordx4 v22, s[8:11], s23 offen offset:2048 nt lds
    s_waitcnt lgkmcnt(0)
    v_readfirstlane_b32 s19, v15
    s_and_b32 s24, s19, 0xffff
    s_waitcnt vmcnt(20)
    buffer_load_dwordx4 v23, s[8:11], s23 offen offset:3072 nt lds
    s_cmp_ge_i32 s20, s26
    s_cbranch_scc1 .Lturn
    s_cmp_lt_u32 s19, 0x10000
    s_cbranch_scc1 .Lload0
    s_cmp_lt_u32 s19, 0x20000
    s_cbranch_scc1 .Lload1
    s_cmp_lt_u32 s19, 0x30000
    s_cbranch_scc1 .Lload2
    s_cmp_lt_u32 s19, 0x40000
    s_cbranch_scc1 .Lload3
    s_cmp_lt_u32 s19, 0x50000
    s_cbranch_scc1 .Lload4
    s_branch .Lload5
.p2align 6
.Lload4:
    s_cmp_lt_i32 s24, s20
    s_cbranch_scc1 .Lspinm4_0
.Lgom4_0:
    s_add_u32 m0, s22, 0x0
    s_add_u32 s23, s16, 0x0
    s_waitcnt vmcnt(21)
    buffer_load_dwordx4 v20, s[8:11], s23 offen offset:0 nt lds
    s_waitcnt vmcnt(21)
    buffer_load_dwordx4 v21, s[8:11], s23 offen offset:1024 nt lds
    s_waitcnt vmcnt(21)
    buffer_load_dwordx4 v22, s[8:11], s23 offen offset:2048 nt lds
    s_waitcnt vmcnt(21)
    buffer_load_dwordx4 v23, s[8:11], s23 offen offset:3072 nt lds
    s_add_u32 m0, s22, 0x1000
    s_add_u32 s23, s16, 0x2000
    s_waitcnt vmcnt(21)
    buffer_load_dwordx4 v20, s[8:11], s23 offen offset:0 nt lds
    s_waitcnt vmcnt(21)
    buffer_load_dwordx4 v21, s[8:11], s23 offen offset:1024 nt lds
    s_add_u32 s21, s20, 6
    v_mov_b32 v14, s21
    ds_write_b32 v8, v14
    s_waitcnt vmcnt(21)
    buffer_load_dwordx4 v22, s[8:11], s23 offen offset:2048 nt lds
    s_waitcnt vmcnt(21)
    buffer_load_dwordx4 v23, s[8:11], s23 offen offset:3072 nt lds
    s_add_u32 m0, s22, 0x2000
    s_add_u32 s23, s16, 0x1000
    s_waitcnt vmcnt(21)
    buffer_load_dwordx4 v20, s[8:11], s23 offen offset:0 nt lds
    s_waitcnt vmcnt(21)
    buffer_load_dwordx4 v21, s[8:11], s23 offen offset:1024 nt lds
    ds_read_b32 v15, v7
    s_add_u32 s20, s20, 1
    s_waitcnt vmcnt(21)
    buffer_load_dwordx4 v22, s[8:11], s23 offen offset:2048 nt lds
    s_waitcnt vmcnt(21)
    buffer_load_dwordx4 v23, s[8:11], s23 offen offset:3072 nt lds
    s_add_u32 m0, s22, 0x3000
    s_add_u32 s23, s16, 0x3000
    s_waitcnt vmcnt(21)
    buffer_load_dwordx4 v20, s[8:11], s23 offen offset:0 nt lds
    s_add_u32 s22, s22, 0x4000
    s_cmp_eq_u32 s22, 0x24000
    s_cselect_b32 s22, 0, s22
    s_waitcnt vmcnt(21)
    buffer_load_dwordx4 v21, s[8:11], s23 offen offset:1024 nt lds
    s_waitcnt vmcnt(21)
    buffer_load_dwordx4 v22, s[8:11], s23 offen offset:2048 nt lds
    s_waitcnt lgkmcnt(0)
    v_readfirstlane_b32 s19, v15
    s_and_b32 s24, s19, 0xffff
    s_waitcnt vmcnt(21)
    buffer_load_dwordx4 v23, s[8:11], s23 offen offset:3072 nt lds
    s_cmp_lt_i32 s24, s20
    s_cbranch_scc1 .Lspinm4_1
.Lgom4_1:
    s_add_u32 m0, s22, 0x0
    s_add_u32 s23, s16, 0x4000
    s_waitcnt vmcnt(21)
    buffer_load_dwordx4 v20, s[8:11], s23 offen offset:0 nt lds
    s_waitcnt vmcnt(21)
    buffer_load_dwordx4 v21, s[8:11], s23 offen offset:1024 nt lds
    s_waitcnt vmcnt(21)
    buffer_load_dwordx4 v22, s[8:11], s23 offen offset:2048 nt lds
    s_waitcnt vmcnt(21)
    buffer_load_dwordx4 v23, s[8:11], s23 offen offset:3072 nt lds
    s_add_u32 m0, s22, 0x1000
    s_add_u32 s23, s16, 0x6000
    s_waitcnt vmcnt(21)
    buffer_load_dwordx4 v20, s[8:11], s23 offen offset:0 nt lds
    s_waitcnt vmcnt(21)
    buffer_load_dwordx4 v21, s[8:11], s23 offen offset:1024 nt lds
    s_add_u32 s21, s20, 6
    v_mov_b32 v14, s21
    ds_write_b32 v8, v14
    s_waitcnt vmcnt(21)
    buffer_load_dwordx4 v22, s[8:11], s23 offen offset:2048 nt lds
    s_waitcnt vmcnt(21)
    buffer_load_dwordx4 v23, s[8:11], s23 offen offset:3072 nt lds
    s_add_u32 m0, s22, 0x2000
    s_add_u32 s23, s16, 0x5000
    s_waitcnt vmcnt(21)
    buffer_load_dwordx4 v20, s[8:11], s23 offen offset:0 nt lds
    s_waitcnt vmcnt(21)
    buffer_load_dwordx4 v21, s[8:11], s23 offen offset:1024 nt lds
    ds_read_b32 v15, v7
    s_add_u32 s20, s20, 1
    s_waitcnt vmcnt(21)
    buffer_load_dwordx4 v22, s[8:11], s23 offen offset:2048 nt lds
    s_waitcnt vmcnt(21)
    buffer_load_dwordx4 v23, s[8:11], s23 offen offset:3072 nt lds
    s_add_u32 m0, s22, 0x3000
    s_add_u32 s23, s16, 0x7000
    s_waitcnt vmcnt(21)
    buffer_load_dwordx4 v20, s[8:11], s23 offen offset:0 nt lds
    s_add_u32 s22, s22, 0x4000
    s_cmp_eq_u32 s22, 0x24000
    s_cselect_b32 s22, 0, s22
    s_waitcnt vmcnt(21)
    buffer_load_dwordx4 v21, s[8:11], s23 offen offset:1024 nt lds
    s_add_u32 s16, s16, 0x10000
    s_cmp_eq_u32 s20, 57
    s_cselect_b32 s16, s27, s16
    s_waitcnt vmcnt(21)
    buffer_load_dwordx4 v22, s[8:11], s23 offen offset:2048 nt lds
    s_waitcnt lgkmcnt(0)
    v_readfirstlane_b32 s19, v15
    s_and_b32 s24, s19, 0xffff
    s_waitcnt vmcnt(21)
    buffer_load_dwordx4 v23, s[8:11], s23 offen offset:3072 nt lds
    s_cmp_ge_i32 s20, s26
    s_cbranch_scc1 .Lturn
    s_cmp_lt_u32 s19, 0x10000
    s_cbranch_scc1 .Lload0
    s_cmp_lt_u32 s19, 0x20000
    s_cbranch_scc1 .Lload1
    s_cmp_lt_u32 s19, 0x30000
    s_cbranch_scc1 .Lload2
    s_cmp_lt_u32 s19, 0x40000
    s_cbranch_scc1 .Lload3
    s_cmp_lt_u32 s19, 0x50000
    s_cbranch_scc1 .Lload4
    s_branch .Lload5
.p2align 6
.Lload5:
    s_cmp_lt_i32 s24, s20
    s_cbranch_scc1 .Lspinm5_0
.Lgom5_0:
    s_add_u32 m0, s22, 0x0
    s_add_u32 s23, s16, 0x0
    s_waitcnt vmcnt(23)
    buffer_load_dwordx4 v20, s[8:11], s23 offen offset:0 nt lds
    s_waitcnt vmcnt(23)
    buffer_load_dwordx4 v21, s[8:11], s23 offen offset:1024 nt lds
    s_waitcnt vmcnt(23)
    buffer_load_dwordx4 v22, s[8:11], s23 offen offset:2048 nt lds
    s_waitcnt vmcnt(23)
    buffer_load_dwordx4 v23, s[8:11], s23 offen offset:3072 nt lds
    s_add_u32 m0, s22, 0x1000
    s_add_u32 s23, s16, 0x2000
    s_waitcnt vmcnt(23)
    buffer_load_dwordx4 v20, s[8:11], s23 offen offset:0 nt lds
    s_waitcnt vmcnt(23)
    buffer_load_dwordx4 v21, s[8:11], s23 offen offset:1024 nt lds
    s_waitcnt vmcnt(23)
    buffer_load_dwordx4 v22, s[8:11], s23 offen offset:2048 nt lds
    s_waitcnt vmcnt(23)
    buffer_load_dwordx4 v23, s[8:11], s23 offen offset:3072 nt lds
    s_add_u32 s21, s20, 6
    v_mov_b32 v14, s21
    ds_write_b32 v8, v14
    s_add_u32 m0, s22, 0x2000
    s_add_u32 s23, s16, 0x1000
    s_waitcnt vmcnt(23)
    buffer_load_dwordx4 v20, s[8:11], s23 offen offset:0 nt lds
    s_waitcnt vmcnt(23)
    buffer_load_dwordx4 v21, s[8:11], s23 offen offset:1024 nt lds
    ds_read_b32 v15, v7
    s_add_u32 s20, s20, 1
    s_waitcnt vmcnt(23)
    buffer_load_dwordx4 v22, s[8:11], s23 offen offset:2048 nt lds
    s_waitcnt vmcnt(23)
    buffer_load_dwordx4 v23, s[8:11], s23 offen offset:3072 nt lds
    s_add_u32 m0, s22, 0x3000
    s_add_u32 s23, s16, 0x3000
    s_waitcnt vmcnt(23)
    buffer_load_dwordx4 v20, s[8:11], s23 offen offset:0 nt lds
    s_add_u32 s22, s22, 0x4000
    s_cmp_eq_u32 s22, 0x24000
    s_cselect_b32 s22, 0, s22
    s_waitcnt vmcnt(23)
    buffer_load_dwordx4 v21, s[8:11], s23 offen offset:1024 nt lds
    s_waitcnt vmcnt(23)
    buffer_load_dwordx4 v22, s[8:11], s23 offen offset:2048 nt lds
    s_waitcnt lgkmcnt(0)
    v_readfirstlane_b32 s19, v15
    s_and_b32 s24, s19, 0xffff
    s_waitcnt vmcnt(23)
    buffer_load_dwordx4 v23, s[8:11], s23 offen offset:3072 nt lds
    s_cmp_lt_i32 s24, s20
    s_cbranch_scc1 .Lspinm5_1
.Lgom5_1:
    s_add_u32 m0, s22, 0x0
    s_add_u32 s23, s16, 0x4000
    s_waitcnt vmcnt(23)
    buffer_load_dwordx4 v20, s[8:11], s23 offen offset:0 nt lds
    s_waitcnt vmcnt(23)
    buffer_load_dwordx4 v21, s[8:11], s23 offen offset:1024 nt lds
    s_waitcnt vmcnt(23)
    buffer_load_dwordx4 v22, s[8:11], s23 offen offset:2048 nt lds
    s_waitcnt vmcnt(23)
    buffer_load_dwordx4 v23, s[8:11], s23 offen offset:3072 nt lds
    s_add_u32 m0, s22, 0x1000
    s_add_u32 s23, s16, 0x6000
    s_waitcnt vmcnt(23)
    buffer_load_dwordx4 v20, s[8:11], s23 offen offset:0 nt lds
    s_waitcnt vmcnt(23)
    buffer_load_dwordx4 v21, s[8:11], s23 offen offset:1024 nt lds
    s_waitcnt vmcnt(23)
    buffer_load_dwordx4 v22, s[8:11], s23 offen offset:2048 nt lds
    s_waitcnt vmcnt(23)
    buffer_load_dwordx4 v23, s[8:11], s23 offen offset:3072 nt lds
    s_add_u32 s21, s20, 6
    v_mov_b32 v14, s21
    ds_write_b32 v8, v14
    s_add_u32 m0, s22, 0x2000
    s_add_u32 s23, s16, 0x5000
    s_waitcnt vmcnt(23)
    buffer_load_dwordx4 v20, s[8:11], s23 offen offset:0 nt lds
    s_waitcnt vmcnt(23)
    buffer_load_dwordx4 v21, s[8:11], s23 offen offset:1024 nt lds
    ds_read_b32 v15, v7
    s_add_u32 s20, s20, 1
    s_waitcnt vmcnt(23)
    buffer_load_dwordx4 v22, s[8:11], s23 offen offset:2048 nt lds
    s_waitcnt vmcnt(23)
    buffer_load_dwordx4 v23, s[8:11], s23 offen offset:3072 nt lds
    s_add_u32 m0, s22, 0x3000
    s_add_u32 s23, s16, 0x7000
    s_waitcnt vmcnt(23)
    buffer_load_dwordx4 v20, s[8:11], s23 offen offset:0 nt lds
    s_add_u32 s22, s22, 0x4000
    s_cmp_eq_u32 s22, 0x24000
    s_cselect_b32 s22, 0, s22
    s_waitcnt vmcnt(23)
    buffer_load_dwordx4 v21, s[8:11], s23 offen offset:1024 nt lds
    s_add_u32 s16, s16, 0x10000
    s_cmp_eq_u32 s20, 57
    s_cselect_b32 s16, s27, s16
    s_waitcnt vmcnt(23)
    buffer_load_dwordx4 v22, s[8:11], s23 offen offset:2048 nt lds
    s_waitcnt lgkmcnt(0)
    v_readfirstlane_b32 s19, v15
    s_and_b32 s24, s19, 0xffff
    s_waitcnt vmcnt(23)
    buffer_load_dwordx4 v23, s[8:11], s23 offen offset:3072 nt lds
    s_cmp_ge_i32 s20, s26
    s_cbranch_scc1 .Lturn
.Lsel:
    s_cmp_lt_u32 s19, 0x10000
    s_cbranch_scc1 .Lload0
    s_cmp_lt_u32 s19, 0x20000
    s_cbranch_scc1 .Lload1
    s_cmp_lt_u32 s19, 0x30000
    s_cbranch_scc1 .Lload2
    s_cmp_lt_u32 s19, 0x40000
    s_cbranch_scc1 .Lload3
    s_cmp_lt_u32 s19, 0x50000
    s_cbranch_scc1 .Lload4
    s_branch .Lload5
.Lturn:
    s_cmp_gt_i32 s20, 57
    s_cbranch_scc1 .Ldrain
    s_mov_b32 s26, 121
    s_mov_b32 s8, s40
    s_mov_b32 s9, s41
    s_branch .Lsel
.Ldrain:
    s_add_u32 s20, s20, 1
    s_cmp_lt_i32 s24, s20
    s_cbranch_scc1 .Lspinw
.Lgow:
    s_mov_b32 m0, 32768
    s_add_u32 s23, s6, 0
    s_waitcnt vmcnt(20)
    buffer_load_dwordx4 v24, s[64:67], s23 offen nt lds
    ds_read_b128 v[248:251], v25
    ds_read_b128 v[252:255], v25 offset:1024
    ds_read_b128 v[244:247], v25 offset:2048
    s_mov_b32 m0, 33792
    s_add_u32 s23, s6, 1024
    s_waitcnt vmcnt(20)
    buffer_load_dwordx4 v24, s[64:67], s23 offen nt lds
    s_mov_b32 m0, 34816
    s_add_u32 s23, s6, 2048
    s_waitcnt vmcnt(20)
    buffer_load_dwordx4 v24, s[64:67], s23 offen nt lds
    s_mov_b32 m0, 35840
    s_add_u32 s23, s6, 3072
    s_waitcnt vmcnt(20)
    buffer_load_dwordx4 v24, s[64:67], s23 offen nt lds
    s_waitcnt lgkmcnt(0)
    v_not_b32 v227, v244
    v_not_b32 v231, v244
    v_not_b32 v235, v244
    v_not_b32 v239, v244
    s_mov_b32 m0, 36864
    s_add_u32 s23, s6, 4096
    s_waitcnt vmcnt(20)
    v_mov_b32 v14, 127
    ds_write_b32 v8, v14
    buffer_load_dwordx4 v24, s[64:67], s23 offen nt lds
    v_mov_b32 v163, v244
    v_mov_b32 v167, v244
    v_mov_b32 v171, v244
    v_mov_b32 v175, v244
    v_mov_b32 v179, v244
    s_mov_b32 m0, 37888
    s_add_u32 s23, s6, 5120
    s_waitcnt vmcnt(20)
    buffer_load_dwordx4 v24, s[64:67], s23 offen nt lds
    v_add_u32 v57, 0x500000, v245
    s_mov_b32 m0, 38912
    s_add_u32 s23, s6, 6144
    s_waitcnt vmcnt(20)
    buffer_load_dwordx4 v24, s[64:67], s23 offen nt lds
    s_mov_b32 exec_hi, 0x00ffffff
    s_mov_b32 m0, 49152
    s_add_u32 s23, s4, 0
    s_waitcnt vmcnt(20)
    buffer_load_dwordx4 v24, s[60:63], s23 offen nt lds
    s_mov_b32 m0, 50048
    s_add_u32 s23, s4, 14336
    s_waitcnt vmcnt(20)
    buffer_load_dwordx4 v24, s[60:63], s23 offen nt lds
    s_mov_b32 m0, 50944
    s_add_u32 s23, s4, 896
    s_waitcnt vmcnt(20)
    buffer_load_dwordx4 v24, s[60:63], s23 offen nt lds
    s_mov_b32 m0, 51840
    s_add_u32 s23, s4, 15232
    s_waitcnt vmcnt(20)
    buffer_load_dwordx4 v24, s[60:63], s23 offen nt lds
    s_mov_b32 m0, 52736
    s_add_u32 s23, s4, 1792
    s_waitcnt vmcnt(20)
    buffer_load_dwordx4 v24, s[60:63], s23 offen nt lds
    s_mov_b32 m0, 53632
    s_add_u32 s23, s4, 16128
    s_waitcnt vmcnt(20)
    buffer_load_dwordx4 v24, s[60:63], s23 offen nt lds
    s_mov_b32 m0, 54528
    s_add_u32 s23, s4, 2688
    s_waitcnt vmcnt(20)
    buffer_load_dwordx4 v24, s[60:63], s23 offen nt lds
    s_mov_b32 m0, 55424
    s_add_u32 s23, s4, 17024
    s_waitcnt vmcnt(20)
    buffer_load_dwordx4 v24, s[60:63], s23 offen nt lds
    s_mov_b32 m0, 56320
    s_add_u32 s23, s4, 3584
    s_waitcnt vmcnt(20)
    buffer_load_dwordx4 v24, s[60:63], s23 offen nt lds
    s_mov_b32 m0, 57216
    s_add_u32 s23, s4, 17920
    s_waitcnt vmcnt(20)
    buffer_load_dwordx4 v24, s[60:63], s23 offen nt lds
    s_mov_b32 m0, 58112
    s_add_u32 s23, s4, 4480
    s_waitcnt vmcnt(20)
    buffer_load_dwordx4 v24, s[60:63], s23 offen nt lds
    s_mov_b32 m0, 59008
    s_add_u32 s23, s4, 18816
    s_waitcnt vmcnt(20)
    buffer_load_dwordx4 v24, s[60:63], s23 offen nt lds
    s_mov_b32 m0, 59904
    s_add_u32 s23, s4, 5376
    s_waitcnt vmcnt(20)
    buffer_load_dwordx4 v24, s[60:63], s23 offen nt lds
    s_mov_b32 m0, 60800
    s_add_u32 s23, s4, 19712
    s_waitcnt vmcnt(20)
    v_mov_b32 v14, 128
    ds_write_b32 v8, v14
    buffer_load_dwordx4 v24, s[60:63], s23 offen nt lds
    s_mov_b32 m0, 61696
    s_add_u32 s23, s4, 6272
    s_waitcnt vmcnt(20)
    buffer_load_dwordx4 v24, s[60:63], s23 offen nt lds
    s_mov_b32 m0, 62592
    s_add_u32 s23, s4, 20608
    s_waitcnt vmcnt(20)
    buffer_load_dwordx4 v24, s[60:63], s23 offen nt lds
    s_mov_b64 exec, -1
    s_waitcnt vmcnt(16) lgkmcnt(0)
    ds_read_b64_tr_b16 v[188:189], v246 offset:0
    ds_read_b64_tr_b16 v[190:191], v246 offset:64
    ds_read_b64_tr_b16 v[192:193], v246 offset:128
    ds_read_b64_tr_b16 v[194:195], v246 offset:192
    ds_read_b64_tr_b16 v[196:197], v246 offset:256
    ds_read_b64_tr_b16 v[198:199], v246 offset:320
    ds_read_b64_tr_b16 v[200:201], v246 offset:384
    ds_read_b64_tr_b16 v[202:203], v246 offset:448
    ds_read_b64_tr_b16 v[204:205], v246 offset:512
    ds_read_b64_tr_b16 v[206:207], v246 offset:576
    ds_read_b64_tr_b16 v[208:209], v246 offset:640
    ds_read_b64_tr_b16 v[210:211], v246 offset:704
    ds_read_b64_tr_b16 v[212:213], v246 offset:768
    ds_read_b64_tr_b16 v[214:215], v246 offset:832
    s_waitcnt lgkmcnt(12)
    v_mfma_f32_16x16x16_bf16 v[128:131], v[248:249], v[188:189], 0
    s_waitcnt lgkmcnt(10)
    v_mfma_f32_16x16x16_bf16 v[132:135], v[248:249], v[192:193], 0
    s_waitcnt lgkmcnt(8)
    v_mfma_f32_16x16x16_bf16 v[136:139], v[248:249], v[196:197], 0
    s_waitcnt lgkmcnt(6)
    v_mfma_f32_16x16x16_bf16 v[140:143], v[248:249], v[200:201], 0
    s_waitcnt lgkmcnt(4)
    v_mfma_f32_16x16x16_bf16 v[144:147], v[248:249], v[204:205], 0
    s_waitcnt lgkmcnt(2)
    v_mfma_f32_16x16x16_bf16 v[148:151], v[248:249], v[208:209], 0
    s_waitcnt lgkmcnt(0)
    v_mfma_f32_16x16x16_bf16 v[152:155], v[248:249], v[212:213], 0
    v_mfma_f32_16x16x16_bf16 v[128:131], v[250:251], v[190:191], v[128:131]
    v_mfma_f32_16x16x16_bf16 v[132:135], v[250:251], v[194:195], v[132:135]
    v_mfma_f32_16x16x16_bf16 v[136:139], v[250:251], v[198:199], v[136:139]
    v_mfma_f32_16x16x16_bf16 v[140:143], v[250:251], v[202:203], v[140:143]
    v_mfma_f32_16x16x16_bf16 v[144:147], v[250:251], v[206:207], v[144:147]
    v_mfma_f32_16x16x16_bf16 v[148:151], v[250:251], v[210:211], v[148:151]
    v_mfma_f32_16x16x16_bf16 v[152:155], v[250:251], v[214:215], v[152:155]
    buffer_load_dwordx4 v[224:227], v245, s[72:75], s76 offen sc1
    buffer_load_dwordx4 v[228:231], v245, s[72:75], s77 offen sc1
    buffer_load_dwordx4 v[232:235], v245, s[72:75], s78 offen sc1
    buffer_load_dwordx4 v[236:239], v245, s[72:75], s79 offen sc1
    s_nop 3
    v_mul_f32 v120, v254, v128
    v_mul_f32 v121, v255, v129
    v_mul_f32 v122, v254, v132
    v_mul_f32 v123, v255, v133
    v_mul_f32 v124, v254, v136
    v_mul_f32 v125, v255, v137
    v_mul_f32 v126, v254, v140
    v_mul_f32 v127, v255, v141
    v_mul_f32 v216, v254, v144
    v_mul_f32 v217, v255, v145
    v_mul_f32 v218, v254, v148
    v_mul_f32 v219, v255, v149
    v_mul_f32 v220, v254, v152
    v_mul_f32 v221, v255, v153
    s_waitcnt vmcnt(12)
    buffer_load_dwordx4 v[224:227], v245, s[72:75], s76 offen sc1
    buffer_load_dwordx4 v[228:231], v245, s[72:75], s77 offen sc1
    buffer_load_dwordx4 v[232:235], v245, s[72:75], s78 offen sc1
    buffer_load_dwordx4 v[236:239], v245, s[72:75], s79 offen sc1
    s_waitcnt vmcnt(8)
    buffer_load_dwordx4 v[224:227], v245, s[72:75], s76 offen sc1
    buffer_load_dwordx4 v[228:231], v245, s[72:75], s77 offen sc1
    buffer_load_dwordx4 v[232:235], v245, s[72:75], s78 offen sc1
    buffer_load_dwordx4 v[236:239], v245, s[72:75], s79 offen sc1
    ds_read_b64_tr_b16 v[64:65], v247 offset:0
    ds_read_b64_tr_b16 v[66:67], v247 offset:3584
    ds_read_b64_tr_b16 v[68:69], v247 offset:64
    ds_read_b64_tr_b16 v[70:71], v247 offset:3648
    ds_read_b64_tr_b16 v[72:73], v247 offset:128
    ds_read_b64_tr_b16 v[74:75], v247 offset:3712
    ds_read_b64_tr_b16 v[76:77], v247 offset:192
    ds_read_b64_tr_b16 v[78:79], v247 offset:3776
    ds_read_b64_tr_b16 v[80:81], v247 offset:256
    ds_read_b64_tr_b16 v[82:83], v247 offset:3840
    ds_read_b64_tr_b16 v[84:85], v247 offset:320
    ds_read_b64_tr_b16 v[86:87], v247 offset:3904
    ds_read_b64_tr_b16 v[88:89], v247 offset:384
    ds_read_b64_tr_b16 v[90:91], v247 offset:3968
    ds_read_b64_tr_b16 v[92:93], v247 offset:448
    ds_read_b64_tr_b16 v[94:95], v247 offset:4032
    ds_read_b64_tr_b16 v[96:97], v247 offset:512
    ds_read_b64_tr_b16 v[98:99], v247 offset:4096
    ds_read_b64_tr_b16 v[100:101], v247 offset:576
    ds_read_b64_tr_b16 v[102:103], v247 offset:4160
    ds_read_b64_tr_b16 v[104:105], v247 offset:640
    ds_read_b64_tr_b16 v[106:107], v247 offset:4224
    ds_read_b64_tr_b16 v[108:109], v247 offset:704
    ds_read_b64_tr_b16 v[110:111], v247 offset:4288
    ds_read_b64_tr_b16 v[112:113], v247 offset:768
    ds_read_b64_tr_b16 v[114:115], v247 offset:4352
    ds_read_b64_tr_b16 v[116:117], v247 offset:832
    ds_read_b64_tr_b16 v[118:119], v247 offset:4416
.Lh1_loop:
    s_waitcnt vmcnt(0)
    v_cmp_ne_u32 s[36:37], v227, v244
    v_cmp_ne_u32 s[38:39], v231, v244
    v_cmp_ne_u32 s[40:41], v235, v244
    v_cmp_ne_u32 s[10:11], v239, v244
    s_or_b64 vcc, s[36:37], s[38:39]
    s_or_b64 vcc, vcc, s[40:41]
    s_or_b64 vcc, vcc, s[10:11]
    s_cbranch_scc0 .Lh1_ok
    s_wqm_b64 exec, s[36:37]
    s_cbranch_execz .Lsk_1
    buffer_load_dwordx4 v[224:227], v245, s[72:75], s76 offen sc1
.Lsk_1:
    s_wqm_b64 exec, s[38:39]
    s_cbranch_execz .Lsk_2
    buffer_load_dwordx4 v[228:231], v245, s[72:75], s77 offen sc1
.Lsk_2:
    s_wqm_b64 exec, s[40:41]
    s_cbranch_execz .Lsk_3
    buffer_load_dwordx4 v[232:235], v245, s[72:75], s78 offen sc1
.Lsk_3:
    s_wqm_b64 exec, s[10:11]
    s_cbranch_execz .Lsk_4
    buffer_load_dwordx4 v[236:239], v245, s[72:75], s79 offen sc1
.Lsk_4:
    s_mov_b64 exec, -1
    s_sub_u32 s29, s29, 1
    s_cbranch_scc0 .Lh1_loop
    s_mov_b32 s29, 40
    s_waitcnt vmcnt(0)
    v_cmp_ne_u32 vcc, v227, v244
    s_wqm_b64 exec, vcc
    s_cbranch_execz .Lsk_5
    buffer_load_dwordx4 v[224:227], v57, s[72:75], s76 offen sc1
.Lsk_5:
    s_mov_b64 exec, -1
    v_cmp_ne_u32 vcc, v231, v244
    s_wqm_b64 exec, vcc
    s_cbranch_execz .Lsk_6
    buffer_load_dwordx4 v[228:231], v57, s[72:75], s77 offen sc1
.Lsk_6:
    s_mov_b64 exec, -1
    v_cmp_ne_u32 vcc, v235, v244
    s_wqm_b64 exec, vcc
    s_cbranch_execz .Lsk_7
    buffer_load_dwordx4 v[232:235], v57, s[72:75], s78 offen sc1
.Lsk_7:
    s_mov_b64 exec, -1
    v_cmp_ne_u32 vcc, v239, v244
    s_wqm_b64 exec, vcc
    s_cbranch_execz .Lsk_8
    buffer_load_dwordx4 v[236:239], v57, s[72:75], s79 offen sc1
.Lsk_8:
    s_mov_b64 exec, -1
    s_waitcnt vmcnt(0)
    s_sub_u32 s25, s25, 1024
    s_cbranch_scc0 .Lh1_loop
    s_mov_b32 s25, 0
.Lh1_ok:
    v_mov_b32 v16, v226
    v_mov_b32 v20, v226
    v_mov_b32 v17, v230
    v_mov_b32 v21, v230
    v_mov_b32 v18, v234
    v_mov_b32 v22, v234
    v_mov_b32 v19, v238
    v_mov_b32 v23, v238
    v_permlane16_swap_b32 v16, v20
    v_permlane16_swap_b32 v17, v21
    v_permlane16_swap_b32 v18, v22
    v_max_f32 v36, v16, v17
    v_permlane16_swap_b32 v19, v23
    v_max_f32 v37, v18, v19
    s_nop 0
    v_max_f32_dpp v36, v36, v36 row_ror:4 row_mask:0xf bank_mask:0xf
    v_max_f32_dpp v37, v37, v37 row_ror:4 row_mask:0xf bank_mask:0xf
    s_nop 0
    v_max_f32_dpp v36, v36, v36 row_ror:8 row_mask:0xf bank_mask:0xf
    v_max_f32_dpp v37, v37, v37 row_ror:8 row_mask:0xf bank_mask:0xf
    v_mov_b32 v38, v36
    v_mov_b32 v39, v37
    s_nop 0
    v_permlane32_swap_b32 v36, v38
    v_permlane32_swap_b32 v37, v39
    v_max_f32 v36, v36, v38
    v_max_f32 v37, v37, v39
    v_sub_f32 v40, v16, v36
    v_sub_f32 v41, v17, v36
    v_sub_f32 v42, v18, v37
    v_sub_f32 v43, v19, v37
    v_exp_f32 v40, v40
    v_exp_f32 v41, v41
    v_exp_f32 v42, v42
    v_exp_f32 v43, v43
    s_mov_b32 vcc_lo, 0xaaaaaaaa
    v_mul_f32 v44, v40, v224
    v_mul_f32 v45, v40, v225
    v_mul_f32 v46, v40, v20
    v_fmac_f32 v44, v41, v228
    v_fmac_f32 v45, v41, v229
    v_fmac_f32 v46, v41, v21
    v_mul_f32 v47, v42, v232
    v_mul_f32 v48, v42, v233
    v_mul_f32 v49, v42, v22
    v_fmac_f32 v47, v43, v236
    v_fmac_f32 v48, v43, v237
    v_fmac_f32 v49, v43, v23
    s_mov_b32 vcc_hi, 0xaaaaaaaa
    v_permlane32_swap_b32 v44, v47
    v_permlane32_swap_b32 v45, v48
    v_permlane32_swap_b32 v46, v49
    v_add_f32 v44, v44, v47
    v_add_f32 v45, v45, v48
    v_add_f32 v46, v46, v49
    v_add_f32_dpp v44, v44, v44 row_ror:4 row_mask:0xf bank_mask:0xf
    v_add_f32_dpp v45, v45, v45 row_ror:4 row_mask:0xf bank_mask:0xf
    v_add_f32_dpp v46, v46, v46 row_ror:4 row_mask:0xf bank_mask:0xf
    s_nop 1
    v_add_f32_dpp v46, v46, v46 row_ror:8 row_mask:0xf bank_mask:0xf
    v_rcp_f32 v46, v46
    v_add_f32_dpp v44, v44, v44 row_ror:8 row_mask:0xf bank_mask:0xf
    v_add_f32_dpp v45, v45, v45 row_ror:8 row_mask:0xf bank_mask:0xf
    v_mul_f32 v44, v44, v46
    v_mul_f32 v45, v45, v46
    v_cvt_pk_bf16_f32 v44, v44, v45
    v_mov_b32 v45, v44
    s_nop 1
    v_permlane32_swap_b32 v44, v45
    s_nop 1
    v_mov_b32_dpp v36, v45 quad_perm:[0,0,0,0] row_mask:0xf bank_mask:0xf
    v_mov_b32_dpp v37, v45 quad_perm:[1,1,1,1] row_mask:0xf bank_mask:0xf
    v_mov_b32_dpp v38, v45 quad_perm:[2,2,2,2] row_mask:0xf bank_mask:0xf
    v_mov_b32_dpp v39, v45 quad_perm:[3,3,3,3] row_mask:0xf bank_mask:0xf
    v_cndmask_b32_dpp v36, v44, v36, vcc quad_perm:[0,0,0,0] row_mask:0xf bank_mask:0xf
    v_cndmask_b32_dpp v37, v44, v37, vcc quad_perm:[1,1,1,1] row_mask:0xf bank_mask:0xf
    v_cndmask_b32_dpp v38, v44, v38, vcc quad_perm:[2,2,2,2] row_mask:0xf bank_mask:0xf
    v_cndmask_b32_dpp v39, v44, v39, vcc quad_perm:[3,3,3,3] row_mask:0xf bank_mask:0xf
    v_cndmask_b32 v48, 0, v36, s[48:49]
    v_cndmask_b32 v49, 0, v37, s[48:49]
    v_cndmask_b32 v50, 0, v38, s[48:49]
    v_cndmask_b32 v51, 0, v39, s[48:49]
    v_cndmask_b32 v52, 0, v36, s[50:51]
    v_cndmask_b32 v53, 0, v37, s[50:51]
    v_cndmask_b32 v54, 0, v38, s[50:51]
    v_cndmask_b32 v55, 0, v39, s[50:51]
    s_waitcnt lgkmcnt(0)
    v_mfma_f32_16x16x32_bf16 v[128:131], v[48:51], v[64:67], 0
    v_mfma_f32_16x16x32_bf16 v[132:135], v[48:51], v[72:75], 0
    v_mfma_f32_16x16x32_bf16 v[128:131], v[52:55], v[68:71], v[128:131]
    v_mfma_f32_16x16x32_bf16 v[136:139], v[48:51], v[80:83], 0
    v_mfma_f32_16x16x32_bf16 v[132:135], v[52:55], v[76:79], v[132:135]
    v_mfma_f32_16x16x32_bf16 v[140:143], v[48:51], v[88:91], 0
    v_mfma_f32_16x16x32_bf16 v[136:139], v[52:55], v[84:87], v[136:139]
    v_mfma_f32_16x16x32_bf16 v[144:147], v[48:51], v[96:99], 0
    v_mfma_f32_16x16x32_bf16 v[140:143], v[52:55], v[92:95], v[140:143]
    v_mfma_f32_16x16x32_bf16 v[148:151], v[48:51], v[104:107], 0
    v_mfma_f32_16x16x32_bf16 v[144:147], v[52:55], v[100:103], v[144:147]
    v_mfma_f32_16x16x32_bf16 v[152:155], v[48:51], v[112:115], 0
    v_mfma_f32_16x16x32_bf16 v[148:151], v[52:55], v[108:111], v[148:151]
    v_mfma_f32_16x16x32_bf16 v[152:155], v[52:55], v[116:119], v[152:155]
    v_fma_f32 v160, v252, v128, v120
    v_fma_f32 v161, v253, v129, v121
    v_fma_f32 v162, v252, v132, v122
    buffer_store_dwordx4 v[160:163], v24, s[72:75], s80 offen offset:0 sc1
    v_fma_f32 v164, v253, v133, v123
    v_fma_f32 v165, v252, v136, v124
    v_fma_f32 v166, v253, v137, v125
    buffer_store_dwordx4 v[164:167], v24, s[72:75], s80 offen offset:1024 sc1
    v_fma_f32 v168, v252, v140, v126
    v_fma_f32 v169, v253, v141, v127
    v_fma_f32 v170, v252, v144, v216
    buffer_store_dwordx4 v[168:171], v24, s[72:75], s80 offen offset:2048 sc1
    v_fma_f32 v172, v253, v145, v217
    v_fma_f32 v173, v252, v148, v218
    v_fma_f32 v174, v253, v149, v219
    buffer_store_dwordx4 v[172:175], v24, s[72:75], s80 offen offset:3072 sc1
    v_fma_f32 v176, v252, v152, v220
    v_fma_f32 v177, v253, v153, v221
    buffer_store_dwordx4 v[176:179], v24, s[72:75], s81 offen offset:0 sc1
    s_waitcnt vmcnt(4)
    v_mov_b32 v14, 0x10080
    ds_write_b32 v8, v14
    s_endpgm
.Lspinm0_0:
    ds_read_b32 v15, v7
    s_waitcnt lgkmcnt(0)
    v_readfirstlane_b32 s24, v15
    s_and_b32 s24, s24, 0xffff
    s_cmp_ge_i32 s24, s20
    s_cbranch_scc1 .Lgom0_0
    s_sleep 1
    s_sub_u32 s25, s25, 1
    s_cbranch_scc0 .Lspinm0_0
    s_mov_b32 s25, 0
    s_branch .Lgom0_0
.Lspinm0_1:
    ds_read_b32 v15, v7
    s_waitcnt lgkmcnt(0)
    v_readfirstlane_b32 s24, v15
    s_and_b32 s24, s24, 0xffff
    s_cmp_ge_i32 s24, s20
    s_cbranch_scc1 .Lgom0_1
    s_sleep 1
    s_sub_u32 s25, s25, 1
    s_cbranch_scc0 .Lspinm0_1
    s_mov_b32 s25, 0
    s_branch .Lgom0_1
.Lspinm1_0:
    ds_read_b32 v15, v7
    s_waitcnt lgkmcnt(0)
    v_readfirstlane_b32 s24, v15
    s_and_b32 s24, s24, 0xffff
    s_cmp_ge_i32 s24, s20
    s_cbranch_scc1 .Lgom1_0
    s_sleep 1
    s_sub_u32 s25, s25, 1
    s_cbranch_scc0 .Lspinm1_0
    s_mov_b32 s25, 0
    s_branch .Lgom1_0
.Lspinm1_1:
    ds_read_b32 v15, v7
    s_waitcnt lgkmcnt(0)
    v_readfirstlane_b32 s24, v15
    s_and_b32 s24, s24, 0xffff
    s_cmp_ge_i32 s24, s20
    s_cbranch_scc1 .Lgom1_1
    s_sleep 1
    s_sub_u32 s25, s25, 1
    s_cbranch_scc0 .Lspinm1_1
    s_mov_b32 s25, 0
    s_branch .Lgom1_1
.Lspinm2_0:
    ds_read_b32 v15, v7
    s_waitcnt lgkmcnt(0)
    v_readfirstlane_b32 s24, v15
    s_and_b32 s24, s24, 0xffff
    s_cmp_ge_i32 s24, s20
    s_cbranch_scc1 .Lgom2_0
    s_sleep 1
    s_sub_u32 s25, s25, 1
    s_cbranch_scc0 .Lspinm2_0
    s_mov_b32 s25, 0
    s_branch .Lgom2_0
.Lspinm2_1:
    ds_read_b32 v15, v7
    s_waitcnt lgkmcnt(0)
    v_readfirstlane_b32 s24, v15
    s_and_b32 s24, s24, 0xffff
    s_cmp_ge_i32 s24, s20
    s_cbranch_scc1 .Lgom2_1
    s_sleep 1
    s_sub_u32 s25, s25, 1
    s_cbranch_scc0 .Lspinm2_1
    s_mov_b32 s25, 0
    s_branch .Lgom2_1
.Lspinm3_0:
    ds_read_b32 v15, v7
    s_waitcnt lgkmcnt(0)
    v_readfirstlane_b32 s24, v15
    s_and_b32 s24, s24, 0xffff
    s_cmp_ge_i32 s24, s20
    s_cbranch_scc1 .Lgom3_0
    s_sleep 1
    s_sub_u32 s25, s25, 1
    s_cbranch_scc0 .Lspinm3_0
    s_mov_b32 s25, 0
    s_branch .Lgom3_0
.Lspinm3_1:
    ds_read_b32 v15, v7
    s_waitcnt lgkmcnt(0)
    v_readfirstlane_b32 s24, v15
    s_and_b32 s24, s24, 0xffff
    s_cmp_ge_i32 s24, s20
    s_cbranch_scc1 .Lgom3_1
    s_sleep 1
    s_sub_u32 s25, s25, 1
    s_cbranch_scc0 .Lspinm3_1
    s_mov_b32 s25, 0
    s_branch .Lgom3_1
.Lspinm4_0:
    ds_read_b32 v15, v7
    s_waitcnt lgkmcnt(0)
    v_readfirstlane_b32 s24, v15
    s_and_b32 s24, s24, 0xffff
    s_cmp_ge_i32 s24, s20
    s_cbranch_scc1 .Lgom4_0
    s_sleep 1
    s_sub_u32 s25, s25, 1
    s_cbranch_scc0 .Lspinm4_0
    s_mov_b32 s25, 0
    s_branch .Lgom4_0
.Lspinm4_1:
    ds_read_b32 v15, v7
    s_waitcnt lgkmcnt(0)
    v_readfirstlane_b32 s24, v15
    s_and_b32 s24, s24, 0xffff
    s_cmp_ge_i32 s24, s20
    s_cbranch_scc1 .Lgom4_1
    s_sleep 1
    s_sub_u32 s25, s25, 1
    s_cbranch_scc0 .Lspinm4_1
    s_mov_b32 s25, 0
    s_branch .Lgom4_1
.Lspinm5_0:
    ds_read_b32 v15, v7
    s_waitcnt lgkmcnt(0)
    v_readfirstlane_b32 s24, v15
    s_and_b32 s24, s24, 0xffff
    s_cmp_ge_i32 s24, s20
    s_cbranch_scc1 .Lgom5_0
    s_sleep 1
    s_sub_u32 s25, s25, 1
    s_cbranch_scc0 .Lspinm5_0
    s_mov_b32 s25, 0
    s_branch .Lgom5_0
.Lspinm5_1:
    ds_read_b32 v15, v7
    s_waitcnt lgkmcnt(0)
    v_readfirstlane_b32 s24, v15
    s_and_b32 s24, s24, 0xffff
    s_cmp_ge_i32 s24, s20
    s_cbranch_scc1 .Lgom5_1
    s_sleep 1
    s_sub_u32 s25, s25, 1
    s_cbranch_scc0 .Lspinm5_1
    s_mov_b32 s25, 0
    s_branch .Lgom5_1
.Lspinw:
    ds_read_b32 v15, v7
    s_waitcnt lgkmcnt(0)
    v_readfirstlane_b32 s24, v15
    s_and_b32 s24, s24, 0xffff
    s_cmp_ge_i32 s24, s20
    s_cbranch_scc1 .Lgow
    s_sleep 1
    s_sub_u32 s25, s25, 1
    s_cbranch_scc0 .Lspinw
    s_mov_b32 s25, 0
    s_branch .Lgow
.Lspinf:
    ds_read_b32 v15, v7
    s_waitcnt lgkmcnt(0)
    v_readfirstlane_b32 s24, v15
    s_and_b32 s24, s24, 0xffff
    s_cmp_ge_i32 s24, 1
    s_cbranch_scc1 .Lgof
    s_sleep 1
    s_sub_u32 s25, s25, 1
    s_cbranch_scc0 .Lspinf
    s_mov_b32 s25, 0
    s_branch .Lgof
.p2align 6
.Lcons2:
    v_and_b32 v58, 1, v2
    v_mul_u32_u24 v60, 896, v58
    v_lshl_add_u32 v60, v3, 4, v60
    v_add_u32 v60, 155648, v60
    v_lshl_add_u32 v61, v3, 3, v4
    v_lshlrev_b32 v61, 7, v61
    v_lshl_add_u32 v61, v5, 3, v61
    v_add_u32 v51, 114688, v61
    v_add_u32 v61, 131072, v61
    v_lshl_add_u32 v63, v3, 2, v4
    v_lshlrev_b32 v63, 7, v63
    v_lshl_add_u32 v63, v5, 3, v63
    v_add_u32 v63, 143360, v63
    s_mul_i32 s6, s4, 224
    v_add_u32 v57, s6, v60
    v_lshlrev_b32 v55, 3, v3
    v_sub_u32 v55, v57, v55
    s_mul_i32 s6, s20, 112
    v_add_u32 v54, s6, v60
    v_lshlrev_b32 v62, 16, v58
    v_bfe_u32 v14, v2, 1, 2
    v_lshl_add_u32 v62, v14, 6, v62
    v_lshl_add_u32 v62, v3, 4, v62
    v_lshlrev_b32 v53, 7, v14
    v_lshl_add_u32 v53, v58, 5, v53
    v_lshrrev_b32 v14, 1, v3
    v_lshl_add_u32 v53, v14, 6, v53
    v_and_b32 v14, 1, v3
    v_lshl_add_u32 v53, v14, 4, v53
    v_bfe_u32 v244, v1, 2, 3
    v_lshlrev_b32 v244, 9, v244
    v_lshl_add_u32 v244, v5, 4, v244
    v_and_b32 v14, 7, v2
    v_lshlrev_b32 v14, 1, v14
    v_xor_b32 v14, v14, v3
    v_lshlrev_b32 v14, 4, v14
    v_lshl_add_u32 v9, v2, 9, v14
    v_lshl_add_u32 v14, v3, 2, v4
    v_and_b32 v15, 7, v14
    v_lshlrev_b32 v15, 5, v15
    v_lshl_add_u32 v15, v5, 3, v15
    v_lshl_add_u32 v10, v14, 9, v15
    v_mov_b32 v7, 159744
    s_mov_b32 s64, 0x50005
    s_mov_b32 s65, 0x50005
    s_mov_b32 s66, 0xa000a
    s_mov_b32 s67, 0xa000a
    s_mov_b32 s68, 0x500050
    s_mov_b32 s69, 0x500050
    s_mov_b32 s70, 0xa000a0
    s_mov_b32 s71, 0xa000a0
    s_mov_b32 s72, 0x5000500
    s_mov_b32 s73, 0x5000500
    s_mov_b32 s74, 0xa000a00
    s_mov_b32 s75, 0xa000a00
    s_mov_b32 s76, 0x50005000
    s_mov_b32 s77, 0x50005000
    s_mov_b32 s78, 0xa000a000
    s_mov_b32 s79, 0xa000a000
    s_mov_b32 s84, 0x3db8aa3b
    s_mov_b32 s80, 4194304
    s_mov_b32 s83, 0
    s_mov_b32 s82, 0
    s_mov_b32 s7, 1664525
    s_lshr_b32 s5, s2, 5
    s_lshl_b32 s5, s5, 13
    s_lshl_b32 s4, s4, 11
    s_add_u32 s5, s5, s4
    s_bfe_u32 s4, s2, 0x30002
    s_lshl_b32 s4, s4, 8
    s_add_u32 s5, s5, s4
    s_add_u32 s5, s5, 0x20000
    s_and_b32 s6, s2, 7
    s_lshl_b32 s6, s6, 4
    s_bfe_u32 s4, s2, 0x40003
    s_or_b32 s6, s6, s4
    s_and_b32 s4, s2, 0x80
    s_or_b32 s6, s6, s4
    s_lshr_b32 s6, s6, 4
    s_lshl_b32 s6, s6, 13
    s_add_u32 s6, s6, 0x20000
    s_add_u32 s4, s6, 0x1000
    s_lshl_b32 s21, s2, 9
    s_add_u32 s21, s21, 0x40000
    s_lshl_b32 s22, s22, 12
    s_lshl_b32 s20, s20, 6
    s_add_u32 s22, s22, s20
    s_add_u32 s22, s22, 0x40000
    s_mov_b32 s36, 0xc0c0c0c
    s_mov_b32 s37, 0xc0c0c0c
    s_mov_b32 s38, 0x30303030
    s_mov_b32 s39, 0x30303030
    s_mov_b32 s40, 0xc0c0c0c0
    s_mov_b32 s41, 0xc0c0c0c0
    s_mov_b32 s42, 0x7060500
    s_mov_b32 s43, 0x7060501
    s_mov_b32 s44, 0x7060502
    s_mov_b32 s45, 0x7060503
    s_mov_b32 s46, 0x0c0c0400
    s_mov_b32 s47, 0x04000c0c
    s_waitcnt vmcnt(23)
    v_mul_lo_u32 v6, v6, s7
    ds_read_b128 v[64:67], v57 offset:0
    ds_read_b128 v[68:71], v57 offset:64
    ds_read_b128 v[72:75], v57 offset:128
    ds_read_b64 v[76:77], v55 offset:192
    v_add_u32 v6, 1013904223, v6
    s_waitcnt vmcnt(19)
    ds_read_b64_tr_b16 v[128:129], v61 offset:0
    ds_read_b64_tr_b16 v[130:131], v61 offset:512
    ds_read_b64_tr_b16 v[132:133], v61 offset:32
    ds_read_b64_tr_b16 v[134:135], v61 offset:544
    ds_read_b64_tr_b16 v[136:137], v61 offset:64
    ds_read_b64_tr_b16 v[138:139], v61 offset:576
    ds_read_b64_tr_b16 v[140:141], v61 offset:96
    ds_read_b64_tr_b16 v[142:143], v61 offset:608
    s_waitcnt vmcnt(15)
    ds_read_b64_tr_b16 v[144:145], v61 offset:4096
    ds_read_b64_tr_b16 v[146:147], v61 offset:4608
    ds_read_b64_tr_b16 v[148:149], v61 offset:4128
    ds_read_b64_tr_b16 v[150:151], v61 offset:4640
    ds_read_b64_tr_b16 v[152:153], v61 offset:4160
    ds_read_b64_tr_b16 v[154:155], v61 offset:4672
    ds_read_b64_tr_b16 v[156:157], v61 offset:4192
    ds_read_b64_tr_b16 v[158:159], v61 offset:4704
    s_waitcnt lgkmcnt(8)
    v_mfma_f32_16x16x32_bf16 v[80:83], v[128:131], v[64:67], 0
    v_mfma_f32_16x16x32_bf16 v[84:87], v[132:135], v[64:67], 0
    v_mfma_f32_16x16x32_bf16 v[88:91], v[136:139], v[64:67], 0
    v_mfma_f32_16x16x32_bf16 v[92:95], v[140:143], v[64:67], 0
    s_waitcnt vmcnt(11)
    ds_read_b64_tr_b16 v[160:161], v61 offset:8192
    ds_read_b64_tr_b16 v[162:163], v61 offset:8704
    ds_read_b64_tr_b16 v[164:165], v61 offset:8224
    ds_read_b64_tr_b16 v[166:167], v61 offset:8736
    ds_read_b64_tr_b16 v[168:169], v61 offset:8256
    ds_read_b64_tr_b16 v[170:171], v61 offset:8768
    ds_read_b64_tr_b16 v[172:173], v61 offset:8288
    ds_read_b64_tr_b16 v[174:175], v61 offset:8800
    s_waitcnt lgkmcnt(8)
    v_mfma_f32_16x16x32_bf16 v[80:83], v[144:147], v[68:71], v[80:83]
    v_mfma_f32_16x16x32_bf16 v[84:87], v[148:151], v[68:71], v[84:87]
    v_mfma_f32_16x16x32_bf16 v[88:91], v[152:155], v[68:71], v[88:91]
    v_mfma_f32_16x16x32_bf16 v[92:95], v[156:159], v[68:71], v[92:95]
    s_waitcnt vmcnt(9)
    ds_read_b64_tr_b16 v[176:177], v63 offset:0
    ds_read_b64_tr_b16 v[178:179], v63 offset:32
    ds_read_b64_tr_b16 v[180:181], v63 offset:64
    ds_read_b64_tr_b16 v[182:183], v63 offset:96
    s_waitcnt lgkmcnt(4)
    v_mfma_f32_16x16x32_bf16 v[80:83], v[160:163], v[72:75], v[80:83]
    v_mfma_f32_16x16x32_bf16 v[84:87], v[164:167], v[72:75], v[84:87]
    v_mfma_f32_16x16x32_bf16 v[88:91], v[168:171], v[72:75], v[88:91]
    v_mfma_f32_16x16x32_bf16 v[92:95], v[172:175], v[72:75], v[92:95]
    s_waitcnt lgkmcnt(0)
    v_mfma_f32_16x16x16_bf16 v[80:83], v[176:177], v[76:77], v[80:83]
    v_mfma_f32_16x16x16_bf16 v[84:87], v[178:179], v[76:77], v[84:87]
    v_mfma_f32_16x16x16_bf16 v[88:91], v[180:181], v[76:77], v[88:91]
    v_mfma_f32_16x16x16_bf16 v[92:95], v[182:183], v[76:77], v[92:95]
    s_nop 5
    v_cndmask_b32 v80, v80, v84, s[36:37]
    v_cndmask_b32 v81, v81, v85, s[36:37]
    v_cndmask_b32 v82, v82, v86, s[36:37]
    v_cndmask_b32 v83, v83, v87, s[36:37]
    v_cndmask_b32 v80, v80, v88, s[38:39]
    v_cndmask_b32 v81, v81, v89, s[38:39]
    v_cndmask_b32 v82, v82, v90, s[38:39]
    v_cndmask_b32 v83, v83, v91, s[38:39]
    v_cndmask_b32 v80, v80, v92, s[40:41]
    v_cndmask_b32 v81, v81, v93, s[40:41]
    v_cndmask_b32 v82, v82, v94, s[40:41]
    v_cndmask_b32 v83, v83, v95, s[40:41]
    v_add_u32 v80, 0x80, v80
    v_add_u32 v81, 0x80, v81
    v_add_u32 v82, 0x80, v82
    v_add_u32 v83, 0x80, v83
    s_mov_b32 exec_lo, 0x00ff00ff
    s_mov_b32 exec_hi, 0x00ff00ff
    v_perm_b32 v44, v80, v6, s42
    v_perm_b32 v45, v81, v6, s43
    v_perm_b32 v46, v82, v6, s44
    v_perm_b32 v47, v83, v6, s45
    buffer_store_dwordx4 v[44:47], v62, s[16:19], s5 offen sc1
    s_mov_b64 exec, -1
    v_mov_b32 v28, 0
    v_mov_b32 v29, 0
    v_mov_b32 v30, 0
    v_mov_b32 v31, 0
    v_mov_b32 v32, 0
    v_mov_b32 v33, 0
    v_mov_b32 v34, 0
    v_mov_b32 v35, 0
    v_mov_b32 v160, 0
    v_mov_b32 v161, 0
    v_mov_b32 v162, 0
    v_mov_b32 v163, 0
    v_mov_b32 v164, 0
    v_mov_b32 v165, 0
    v_mov_b32 v166, 0
    v_mov_b32 v167, 0
    v_mov_b32 v168, 0
    v_mov_b32 v169, 0
    v_mov_b32 v170, 0
    v_mov_b32 v171, 0
    v_mov_b32 v172, 0
    v_mov_b32 v173, 0
    v_mov_b32 v174, 0
    v_mov_b32 v175, 0
    v_mov_b32 v176, 0
    v_mov_b32 v177, 0
    v_mov_b32 v178, 0
    v_mov_b32 v179, 0
    v_mov_b32 v180, 0
    v_mov_b32 v181, 0
    v_mov_b32 v182, 0
    v_mov_b32 v183, 0
    v_mov_b32 v184, 0
    v_mov_b32 v185, 0
    v_mov_b32 v186, 0
    v_mov_b32 v187, 0
    v_mov_b32 v188, 0
    v_mov_b32 v189, 0
    v_mov_b32 v190, 0
    v_mov_b32 v191, 0
    v_mov_b32 v11, 0xff7fffff
    v_mov_b32 v13, 0
    v_lshlrev_b32 v57, 3, v1
    v_add_u32 v57, 158720, v57
    v_bfe_u32 v58, v2, 1, 1
    v_lshlrev_b32 v245, 6, v58
    v_lshl_add_u32 v245, v3, 4, v245
    v_add_u32 v245, 147456, v245
    v_lshlrev_b32 v58, 9, v58
    v_lshl_add_u32 v58, v3, 4, v58
    v_add_u32 v58, 158720, v58
    s_waitcnt vmcnt(1)
    s_mov_b32 s85, 3
    s_cmp_ge_u32 s83, s85
    s_cbranch_scc1 .Lpd_9
.Lps_10:
    ds_read_b32 v14, v7
    s_waitcnt lgkmcnt(0)
    v_readfirstlane_b32 s83, v14
    s_cmp_ge_u32 s83, s85
    s_cbranch_scc1 .Lpd_9
    s_sleep 1
    s_sub_u32 s80, s80, 1
    s_cbranch_scc0 .Lps_10
    s_mov_b32 s80, 0
.Lpd_9:
    buffer_load_dwordx4 v[64:67], v56, s[16:19], s6 offen offset:0 sc1
    buffer_load_dwordx4 v[68:71], v56, s[16:19], s6 offen offset:1024 sc1
    buffer_load_dwordx4 v[72:75], v56, s[16:19], s6 offen offset:2048 sc1
    buffer_load_dwordx4 v[76:79], v56, s[16:19], s6 offen offset:3072 sc1
    buffer_load_dwordx4 v[80:83], v56, s[16:19], s4 offen offset:0 sc1
    buffer_load_dwordx4 v[84:87], v56, s[16:19], s4 offen offset:1024 sc1
    buffer_load_dwordx4 v[88:91], v56, s[16:19], s4 offen offset:2048 sc1
    buffer_load_dwordx4 v[92:95], v56, s[16:19], s4 offen offset:3072 sc1
    ds_read_b128 v[96:99], v54 offset:0
    ds_read_b128 v[100:103], v54 offset:64
    ds_read_b64_tr_b16 v[128:129], v51 offset:0
    ds_read_b64_tr_b16 v[130:131], v51 offset:512
    ds_read_b64_tr_b16 v[132:133], v51 offset:32
    ds_read_b64_tr_b16 v[134:135], v51 offset:544
    ds_read_b64_tr_b16 v[136:137], v51 offset:64
    ds_read_b64_tr_b16 v[138:139], v51 offset:576
    ds_read_b64_tr_b16 v[140:141], v51 offset:96
    ds_read_b64_tr_b16 v[142:143], v51 offset:608
    ds_read_b64_tr_b16 v[144:145], v51 offset:4096
    ds_read_b64_tr_b16 v[146:147], v51 offset:4608
    ds_read_b64_tr_b16 v[148:149], v51 offset:4128
    ds_read_b64_tr_b16 v[150:151], v51 offset:4640
    ds_read_b64_tr_b16 v[152:153], v51 offset:4160
    ds_read_b64_tr_b16 v[154:155], v51 offset:4672
    ds_read_b64_tr_b16 v[156:157], v51 offset:4192
    ds_read_b64_tr_b16 v[158:159], v51 offset:4704
    v_add_u32 v52, 157696, v56
    ds_read_b128 v[208:211], v52
    v_add_u32 v52, 155648, v56
    ds_read_b128 v[212:215], v52
    ds_read_b128 v[216:219], v52 offset:896
    v_mov_b32 v14, 0x20001
    s_waitcnt lgkmcnt(3)
    ds_write_b32 v8, v14
    v_mfma_f32_16x16x32_bf16 v[104:107], v[128:131], v[96:99], 0
    v_mfma_f32_16x16x32_bf16 v[108:111], v[132:135], v[96:99], 0
    v_mfma_f32_16x16x32_bf16 v[112:115], v[136:139], v[96:99], 0
    v_mfma_f32_16x16x32_bf16 v[116:119], v[140:143], v[96:99], 0
    v_mfma_f32_16x16x32_bf16 v[104:107], v[144:147], v[100:103], v[104:107]
    v_mfma_f32_16x16x32_bf16 v[108:111], v[148:151], v[100:103], v[108:111]
    v_mfma_f32_16x16x32_bf16 v[112:115], v[152:155], v[100:103], v[112:115]
    v_mfma_f32_16x16x32_bf16 v[116:119], v[156:159], v[100:103], v[116:119]
    s_nop 5
    v_cndmask_b32 v104, v104, v108, s[36:37]
    v_cndmask_b32 v105, v105, v109, s[36:37]
    v_cndmask_b32 v106, v106, v110, s[36:37]
    v_cndmask_b32 v107, v107, v111, s[36:37]
    v_cndmask_b32 v104, v104, v112, s[38:39]
    v_cndmask_b32 v105, v105, v113, s[38:39]
    v_cndmask_b32 v106, v106, v114, s[38:39]
    v_cndmask_b32 v107, v107, v115, s[38:39]
    v_cndmask_b32 v104, v104, v116, s[40:41]
    v_cndmask_b32 v105, v105, v117, s[40:41]
    v_cndmask_b32 v106, v106, v118, s[40:41]
    v_cndmask_b32 v107, v107, v119, s[40:41]
    v_add_u32 v104, 0x80, v104
    v_add_u32 v105, 0x80, v105
    v_add_u32 v106, 0x80, v106
    v_add_u32 v107, 0x80, v107
    s_mov_b32 exec_lo, 0x00ff00ff
    s_mov_b32 exec_hi, 0x00ff00ff
    v_perm_b32 v120, v104, v6, s42
    v_perm_b32 v121, v105, v6, s43
    v_perm_b32 v122, v106, v6, s44
    v_perm_b32 v123, v107, v6, s45
    buffer_store_dwordx4 v[120:123], v53, s[16:19], s21 offen sc1
    s_mov_b64 exec, -1
    s_waitcnt lgkmcnt(0)
    v_lshlrev_b32 v224, 16, v208
    v_and_b32 v225, 0xffff0000, v208
    v_lshlrev_b32 v226, 16, v212
    v_and_b32 v227, 0xffff0000, v212
    v_mul_f32 v224, v224, v226
    v_mul_f32 v225, v225, v227
    v_cvt_pk_bf16_f32 v226, v224, v225
    v_lshlrev_b32 v224, 16, v226
    v_and_b32 v225, 0xffff0000, v226
    v_add_f32 v220, v224, v225
    v_lshlrev_b32 v224, 16, v209
    v_and_b32 v225, 0xffff0000, v209
    v_lshlrev_b32 v226, 16, v213
    v_and_b32 v227, 0xffff0000, v213
    v_mul_f32 v224, v224, v226
    v_mul_f32 v225, v225, v227
    v_cvt_pk_bf16_f32 v226, v224, v225
    v_lshlrev_b32 v224, 16, v226
    v_and_b32 v225, 0xffff0000, v226
    v_add_f32 v220, v220, v224
    v_add_f32 v220, v220, v225
    v_lshlrev_b32 v224, 16, v210
    v_and_b32 v225, 0xffff0000, v210
    v_lshlrev_b32 v226, 16, v214
    v_and_b32 v227, 0xffff0000, v214
    v_mul_f32 v224, v224, v226
    v_mul_f32 v225, v225, v227
    v_cvt_pk_bf16_f32 v226, v224, v225
    v_lshlrev_b32 v224, 16, v226
    v_and_b32 v225, 0xffff0000, v226
    v_add_f32 v220, v220, v224
    v_add_f32 v220, v220, v225
    v_lshlrev_b32 v224, 16, v211
    v_and_b32 v225, 0xffff0000, v211
    v_lshlrev_b32 v226, 16, v215
    v_and_b32 v227, 0xffff0000, v215
    v_mul_f32 v224, v224, v226
    v_mul_f32 v225, v225, v227
    v_cvt_pk_bf16_f32 v226, v224, v225
    v_lshlrev_b32 v224, 16, v226
    v_and_b32 v225, 0xffff0000, v226
    v_add_f32 v220, v220, v224
    v_add_f32 v220, v220, v225
    v_lshlrev_b32 v224, 16, v208
    v_and_b32 v225, 0xffff0000, v208
    v_lshlrev_b32 v226, 16, v216
    v_and_b32 v227, 0xffff0000, v216
    v_mul_f32 v224, v224, v226
    v_mul_f32 v225, v225, v227
    v_cvt_pk_bf16_f32 v226, v224, v225
    v_lshlrev_b32 v224, 16, v226
    v_and_b32 v225, 0xffff0000, v226
    v_add_f32 v221, v224, v225
    v_lshlrev_b32 v224, 16, v209
    v_and_b32 v225, 0xffff0000, v209
    v_lshlrev_b32 v226, 16, v217
    v_and_b32 v227, 0xffff0000, v217
    v_mul_f32 v224, v224, v226
    v_mul_f32 v225, v225, v227
    v_cvt_pk_bf16_f32 v226, v224, v225
    v_lshlrev_b32 v224, 16, v226
    v_and_b32 v225, 0xffff0000, v226
    v_add_f32 v221, v221, v224
    v_add_f32 v221, v221, v225
    v_lshlrev_b32 v224, 16, v210
    v_and_b32 v225, 0xffff0000, v210
    v_lshlrev_b32 v226, 16, v218
    v_and_b32 v227, 0xffff0000, v218
    v_mul_f32 v224, v224, v226
    v_mul_f32 v225, v225, v227
    v_cvt_pk_bf16_f32 v226, v224, v225
    v_lshlrev_b32 v224, 16, v226
    v_and_b32 v225, 0xffff0000, v226
    v_add_f32 v221, v221, v224
    v_add_f32 v221, v221, v225
    v_lshlrev_b32 v224, 16, v211
    v_and_b32 v225, 0xffff0000, v211
    v_lshlrev_b32 v226, 16, v219
    v_and_b32 v227, 0xffff0000, v219
    v_mul_f32 v224, v224, v226
    v_mul_f32 v225, v225, v227
    v_cvt_pk_bf16_f32 v226, v224, v225
    v_lshlrev_b32 v224, 16, v226
    v_and_b32 v225, 0xffff0000, v226
    v_add_f32 v221, v221, v224
    v_add_f32 v221, v221, v225
    s_nop 1
    v_permlane32_swap_b32 v220, v221
    v_add_f32 v220, v220, v221
    v_mov_b32 v221, v220
    s_nop 1
    v_permlane16_swap_b32 v220, v221
    v_add_f32 v220, v220, v221
    s_nop 1
    v_add_f32_dpp v220, v220, v220 row_ror:8 row_mask:0xf bank_mask:0xf
    s_nop 1
    v_add_f32_dpp v220, v220, v220 row_ror:4 row_mask:0xf bank_mask:0xf
    s_nop 1
    v_add_f32_dpp v220, v220, v220 row_ror:2 row_mask:0xf bank_mask:0xf
    s_nop 1
    v_add_f32_dpp v220, v220, v220 row_ror:1 row_mask:0xf bank_mask:0xf
    v_cvt_pk_bf16_f32 v220, v220, v220
    v_and_b32 v220, 0xffff0000, v220
    v_mul_f32 v220, 0xbfb8aa3b, v220
    v_exp_f32 v220, v220
    s_nop 0
    v_add_f32 v220, 1.0, v220
    v_rcp_f32 v206, v220
    s_nop 0
    v_cvt_pk_bf16_f32 v206, v206, v206
    v_and_b32 v206, 0xffff0000, v206
    v_sub_f32 v254, 1.0, v206
    v_cvt_pk_bf16_f32 v254, v254, v254
    v_and_b32 v254, 0xffff0000, v254
    v_mov_b32 v207, v206
    v_mov_b32 v255, v254
    s_nop 1
    v_permlane32_swap_b32 v206, v207
    v_permlane32_swap_b32 v254, v255
.Lqchk:
    s_waitcnt vmcnt(8)
    v_perm_b32 v14, v65, v64, s46
    v_perm_b32 v15, v67, v66, s47
    v_and_b32 v64, 0xffffff00, v64
    v_and_b32 v65, 0xffffff00, v65
    v_and_b32 v66, 0xffffff00, v66
    v_and_b32 v67, 0xffffff00, v67
    v_xor_b32 v14, v14, v6
    v_xor_b32 v36, v14, v15
    s_waitcnt vmcnt(7)
    v_perm_b32 v14, v69, v68, s46
    v_perm_b32 v15, v71, v70, s47
    v_and_b32 v68, 0xffffff00, v68
    v_and_b32 v69, 0xffffff00, v69
    v_and_b32 v70, 0xffffff00, v70
    v_and_b32 v71, 0xffffff00, v71
    v_xor_b32 v14, v14, v6
    v_xor_b32 v14, v14, v15
    v_or_b32 v36, v36, v14
    s_waitcnt vmcnt(6)
    v_perm_b32 v14, v73, v72, s46
    v_perm_b32 v15, v75, v74, s47
    v_and_b32 v72, 0xffffff00, v72
    v_and_b32 v73, 0xffffff00, v73
    v_and_b32 v74, 0xffffff00, v74
    v_and_b32 v75, 0xffffff00, v75
    v_xor_b32 v14, v14, v6
    v_xor_b32 v14, v14, v15
    v_or_b32 v36, v36, v14
    v_pk_add_f32 v[64:65], v[64:65], v[72:73]
    v_pk_add_f32 v[66:67], v[66:67], v[74:75]
    s_waitcnt vmcnt(5)
    v_perm_b32 v14, v77, v76, s46
    v_perm_b32 v15, v79, v78, s47
    v_and_b32 v76, 0xffffff00, v76
    v_and_b32 v77, 0xffffff00, v77
    v_and_b32 v78, 0xffffff00, v78
    v_and_b32 v79, 0xffffff00, v79
    v_xor_b32 v14, v14, v6
    v_xor_b32 v14, v14, v15
    v_or_b32 v36, v36, v14
    v_pk_add_f32 v[68:69], v[68:69], v[76:77]
    v_pk_add_f32 v[70:71], v[70:71], v[78:79]
    s_waitcnt vmcnt(4)
    v_perm_b32 v14, v81, v80, s46
    v_perm_b32 v15, v83, v82, s47
    v_and_b32 v80, 0xffffff00, v80
    v_and_b32 v81, 0xffffff00, v81
    v_and_b32 v82, 0xffffff00, v82
    v_and_b32 v83, 0xffffff00, v83
    v_xor_b32 v14, v14, v6
    v_xor_b32 v14, v14, v15
    v_or_b32 v36, v36, v14
    v_pk_add_f32 v[64:65], v[64:65], v[80:81]
    v_pk_add_f32 v[66:67], v[66:67], v[82:83]
    s_waitcnt vmcnt(3)
    v_perm_b32 v14, v85, v84, s46
    v_perm_b32 v15, v87, v86, s47
    v_and_b32 v84, 0xffffff00, v84
    v_and_b32 v85, 0xffffff00, v85
    v_and_b32 v86, 0xffffff00, v86
    v_and_b32 v87, 0xffffff00, v87
    v_xor_b32 v14, v14, v6
    v_xor_b32 v14, v14, v15
    v_or_b32 v36, v36, v14
    v_pk_add_f32 v[68:69], v[68:69], v[84:85]
    v_pk_add_f32 v[70:71], v[70:71], v[86:87]
    s_waitcnt vmcnt(2)
    v_perm_b32 v14, v89, v88, s46
    v_perm_b32 v15, v91, v90, s47
    v_and_b32 v88, 0xffffff00, v88
    v_and_b32 v89, 0xffffff00, v89
    v_and_b32 v90, 0xffffff00, v90
    v_and_b32 v91, 0xffffff00, v91
    v_xor_b32 v14, v14, v6
    v_xor_b32 v14, v14, v15
    v_or_b32 v36, v36, v14
    v_pk_add_f32 v[64:65], v[64:65], v[88:89]
    v_pk_add_f32 v[66:67], v[66:67], v[90:91]
    s_waitcnt vmcnt(1)
    v_perm_b32 v14, v93, v92, s46
    v_perm_b32 v15, v95, v94, s47
    v_and_b32 v92, 0xffffff00, v92
    v_and_b32 v93, 0xffffff00, v93
    v_and_b32 v94, 0xffffff00, v94
    v_and_b32 v95, 0xffffff00, v95
    v_xor_b32 v14, v14, v6
    v_xor_b32 v14, v14, v15
    v_or_b32 v36, v36, v14
    v_pk_add_f32 v[68:69], v[68:69], v[92:93]
    v_pk_add_f32 v[70:71], v[70:71], v[94:95]
    v_cmp_ne_u32 vcc, 0, v36
    s_cbranch_vccz .Lqok
    s_sleep 6
    buffer_load_dwordx4 v[64:67], v56, s[16:19], s6 offen offset:0 sc1
    buffer_load_dwordx4 v[68:71], v56, s[16:19], s6 offen offset:1024 sc1
    buffer_load_dwordx4 v[72:75], v56, s[16:19], s6 offen offset:2048 sc1
    buffer_load_dwordx4 v[76:79], v56, s[16:19], s6 offen offset:3072 sc1
    buffer_load_dwordx4 v[80:83], v56, s[16:19], s4 offen offset:0 sc1
    buffer_load_dwordx4 v[84:87], v56, s[16:19], s4 offen offset:1024 sc1
    buffer_load_dwordx4 v[88:91], v56, s[16:19], s4 offen offset:2048 sc1
    buffer_load_dwordx4 v[92:95], v56, s[16:19], s4 offen offset:3072 sc1
    buffer_load_dwordx4 v[240:243], v244, s[16:19], s22 offen sc1
    s_sub_u32 s80, s80, 64
    s_cbranch_scc0 .Lqchk
    s_mov_b32 s80, 0
    s_waitcnt vmcnt(0)
.Lqok:
    v_cvt_pk_bf16_f32 v44, v64, v65
    v_cvt_pk_bf16_f32 v45, v66, v67
    v_cvt_pk_bf16_f32 v46, v68, v69
    v_cvt_pk_bf16_f32 v47, v70, v71
    ds_write_b64 v57, v[44:45]
    ds_write_b64 v57, v[46:47] offset:512
    buffer_load_dwordx4 v[240:243], v244, s[16:19], s22 offen sc1
    s_waitcnt lgkmcnt(0)
    ds_read_b128 v[128:131], v58 offset:0
    ds_read_b128 v[132:135], v58 offset:64
    ds_read_b128 v[136:139], v58 offset:128
    ds_read_b128 v[140:143], v58 offset:192
    ds_read_b128 v[144:147], v58 offset:256
    ds_read_b128 v[148:151], v58 offset:320
    ds_read_b128 v[152:155], v58 offset:384
    ds_read_b128 v[156:159], v58 offset:448
    s_mov_b32 s23, 0x20000
    v_readfirstlane_b32 s20, v6
    s_add_u32 s52, s58, 0x500000
    s_addc_u32 s53, s59, 0
    s_lshl_b32 s8, s2, 8
    s_mov_b32 s36, 0x10000000
    s_mov_b32 s37, 0x100000
    s_mov_b32 s38, 0x10001000
    s_mov_b32 s39, 0x101000
    s_lshl_b32 s21, s2, 8
    s_add_u32 s21, s21, 0x500000
    s_mov_b32 s85, 1
.p2align 6
.Lktile:
    v_add_u32 v16, s82, v9
    v_xor_b32 v17, 64, v16
    v_xor_b32 v18, 128, v16
    v_xor_b32 v19, 192, v16
    s_cmp_ge_u32 s83, s85
    s_cbranch_scc1 .Lpd_11
.Lps_12:
    ds_read_b32 v14, v7
    s_waitcnt lgkmcnt(0)
    v_readfirstlane_b32 s83, v14
    s_cmp_ge_u32 s83, s85
    s_cbranch_scc1 .Lpd_11
    s_sleep 1
    s_sub_u32 s80, s80, 1
    s_cbranch_scc0 .Lps_12
    s_mov_b32 s80, 0
.Lpd_11:
    ds_read_b128 v[64:67], v16 offset:0
    ds_read_b128 v[68:71], v16 offset:8192
    ds_read_b128 v[72:75], v17 offset:0
    ds_read_b128 v[76:79], v17 offset:8192
    ds_read_b128 v[80:83], v18 offset:0
    ds_read_b128 v[84:87], v18 offset:8192
    ds_read_b128 v[88:91], v19 offset:0
    ds_read_b128 v[92:95], v19 offset:8192
    ds_read_b128 v[96:99], v16 offset:256
    ds_read_b128 v[100:103], v16 offset:8448
    ds_read_b128 v[104:107], v17 offset:256
    ds_read_b128 v[108:111], v17 offset:8448
    ds_read_b128 v[112:115], v18 offset:256
    ds_read_b128 v[116:119], v18 offset:8448
    ds_read_b128 v[120:123], v19 offset:256
    ds_read_b128 v[124:127], v19 offset:8448
    s_add_u32 s85, s85, 1
    s_or_b32 s15, s85, s23
    v_mov_b32 v14, s15
    s_waitcnt lgkmcnt(15)
    v_mfma_f32_16x16x32_bf16 v[36:39], v[64:67], v[128:131], 0
    s_waitcnt lgkmcnt(14)
    v_mfma_f32_16x16x32_bf16 v[40:43], v[68:71], v[128:131], 0
    s_waitcnt lgkmcnt(13)
    v_mfma_f32_16x16x32_bf16 v[36:39], v[72:75], v[132:135], v[36:39]
    s_waitcnt lgkmcnt(12)
    v_mfma_f32_16x16x32_bf16 v[40:43], v[76:79], v[132:135], v[40:43]
    s_waitcnt lgkmcnt(11)
    v_mfma_f32_16x16x32_bf16 v[36:39], v[80:83], v[136:139], v[36:39]
    s_waitcnt lgkmcnt(10)
    v_mfma_f32_16x16x32_bf16 v[40:43], v[84:87], v[136:139], v[40:43]
    s_waitcnt lgkmcnt(9)
    v_mfma_f32_16x16x32_bf16 v[36:39], v[88:91], v[140:143], v[36:39]
    s_waitcnt lgkmcnt(8)
    v_mfma_f32_16x16x32_bf16 v[40:43], v[92:95], v[140:143], v[40:43]
    s_waitcnt lgkmcnt(7)
    v_mfma_f32_16x16x32_bf16 v[36:39], v[96:99], v[144:147], v[36:39]
    s_waitcnt lgkmcnt(6)
    v_mfma_f32_16x16x32_bf16 v[40:43], v[100:103], v[144:147], v[40:43]
    s_waitcnt lgkmcnt(5)
    v_mfma_f32_16x16x32_bf16 v[36:39], v[104:107], v[148:151], v[36:39]
    s_waitcnt lgkmcnt(4)
    v_mfma_f32_16x16x32_bf16 v[40:43], v[108:111], v[148:151], v[40:43]
    s_waitcnt lgkmcnt(3)
    v_mfma_f32_16x16x32_bf16 v[36:39], v[112:115], v[152:155], v[36:39]
    s_waitcnt lgkmcnt(2)
    v_mfma_f32_16x16x32_bf16 v[40:43], v[116:119], v[152:155], v[40:43]
    s_waitcnt lgkmcnt(1)
    v_mfma_f32_16x16x32_bf16 v[36:39], v[120:123], v[156:159], v[36:39]
    s_waitcnt lgkmcnt(0)
    ds_write_b32 v8, v14
    v_mfma_f32_16x16x32_bf16 v[40:43], v[124:127], v[156:159], v[40:43]
    s_add_u32 s82, s82, 0x4000
    s_cmp_eq_u32 s82, 0x24000
    s_cselect_b32 s82, 0, s82
    s_nop 4
    v_cvt_pk_bf16_f32 v44, v36, v37
    v_cvt_pk_bf16_f32 v45, v38, v39
    v_cvt_pk_bf16_f32 v46, v40, v41
    v_cvt_pk_bf16_f32 v47, v42, v43
    s_mov_b64 exec, s[64:65]
    ds_write_b128 v245, v[44:47]
    s_mov_b64 exec, -1
    v_max3_f32 v14, v36, v37, v38
    v_max3_f32 v15, v39, v40, v41
    v_max3_f32 v14, v14, v42, v43
    v_max3_f32 v11, v14, v15, v11
    v_add_u32 v245, 128, v245
    s_cmp_gt_u32 s85, 64
    s_cbranch_scc1 .Lkdone
    s_bitcmp0_b64 s[36:37], s85
    s_cbranch_scc1 .Lktile
    s_xor_b32 s24, s8, 0x1100
    s_load_dword s24, s[52:53], s24
    s_xor_b32 s25, s8, 0x1900
    s_load_dword s25, s[52:53], s25
    s_xor_b32 s26, s8, 0x2200
    s_load_dword s26, s[52:53], s26
    s_xor_b32 s27, s8, 0x2a00
    s_load_dword s27, s[52:53], s27
    s_xor_b32 s28, s8, 0x4300
    s_load_dword s28, s[52:53], s28
    s_xor_b32 s29, s8, 0x4b00
    s_load_dword s29, s[52:53], s29
    s_xor_b32 s30, s8, 0x8400
    s_load_dword s30, s[52:53], s30
    s_xor_b32 s31, s8, 0x8c00
    s_load_dword s31, s[52:53], s31
    s_xor_b32 s32, s8, 0x3500
    s_load_dword s32, s[52:53], s32
    s_xor_b32 s33, s8, 0x3d00
    s_load_dword s33, s[52:53], s33
    s_xor_b32 s34, s8, 0xc600
    s_load_dword s34, s[52:53], s34
    s_xor_b32 s35, s8, 0xce00
    s_load_dword s35, s[52:53], s35
    s_xor_b32 s56, s8, 0xf700
    s_load_dword s56, s[52:53], s56
    s_xor_b32 s57, s8, 0xff00
    s_load_dword s57, s[52:53], s57
    s_mov_b64 exec, 1
    buffer_store_dword v6, v59, s[16:19], s21 offen sc1
    s_mov_b64 exec, -1
    s_add_u32 s21, s21, 0x10000
    s_mov_b32 s15, 0
    s_waitcnt lgkmcnt(0)
    s_add_u32 s52, s52, 0x10000
    s_addc_u32 s53, s53, 0
    s_cmp_eq_u32 s24, s20
    s_addc_u32 s15, s15, 0
    s_cmp_eq_u32 s25, s20
    s_addc_u32 s15, s15, 0
    s_cmp_eq_u32 s26, s20
    s_addc_u32 s15, s15, 0
    s_cmp_eq_u32 s27, s20
    s_addc_u32 s15, s15, 0
    s_cmp_eq_u32 s28, s20
    s_addc_u32 s15, s15, 0
    s_cmp_eq_u32 s29, s20
    s_addc_u32 s15, s15, 0
    s_cmp_eq_u32 s30, s20
    s_addc_u32 s15, s15, 0
    s_cmp_eq_u32 s31, s20
    s_addc_u32 s15, s15, 0
    s_cmp_eq_u32 s32, s20
    s_addc_u32 s15, s15, 0
    s_cmp_eq_u32 s33, s20
    s_addc_u32 s15, s15, 0
    s_cmp_eq_u32 s34, s20
    s_addc_u32 s15, s15, 0
    s_cmp_eq_u32 s35, s20
    s_addc_u32 s15, s15, 0
    s_cmp_eq_u32 s56, s20
    s_addc_u32 s15, s15, 0
    s_cmp_eq_u32 s57, s20
    s_addc_u32 s15, s15, 0
    s_mov_b32 s23, 0
    s_cmp_ge_u32 s15, 3
    s_cselect_b32 s23, 0x10000, s23
    s_cmp_ge_u32 s15, 6
    s_cselect_b32 s23, 0x20000, s23
    s_cmp_ge_u32 s15, 10
    s_cselect_b32 s23, 0x30000, s23
    s_cmp_ge_u32 s15, 12
    s_cselect_b32 s23, 0x40000, s23
    s_cmp_ge_u32 s15, 13
    s_cselect_b32 s23, 0x50000, s23
    s_branch .Lktile
.Lkdone:
    v_mov_b32 v15, v11
    v_subrev_u32 v245, 8192, v245
    s_nop 0
    v_permlane16_swap_b32 v11, v15
    v_max_f32 v11, v11, v15
    v_mov_b32 v15, v11
    s_nop 1
    v_permlane32_swap_b32 v11, v15
    v_max_f32 v11, v11, v15
    v_cvt_pk_bf16_f32 v11, v11, v11
    v_and_b32 v11, 0xffff0000, v11
    v_mul_f32 v12, s84, v11
.Lhchk:
    s_waitcnt vmcnt(0)
    v_perm_b32 v14, v241, v240, s46
    v_perm_b32 v15, v243, v242, s47
    v_xor_b32 v14, v14, v15
    v_cmp_ne_u32 vcc, v14, v6
    s_cbranch_vccz .Lhok
    buffer_load_dwordx4 v[240:243], v244, s[16:19], s22 offen sc1
    s_sub_u32 s80, s80, 64
    s_cbranch_scc0 .Lhchk
    s_mov_b32 s80, 0
    s_waitcnt vmcnt(0)
.Lhok:
    v_and_b32 v208, 0xffffff00, v240
    v_and_b32 v209, 0xffffff00, v241
    v_and_b32 v210, 0xffffff00, v242
    v_and_b32 v211, 0xffffff00, v243
    v_add_f32_dpp v208, v208, v208 row_ror:4 row_mask:0xf bank_mask:0xf
    v_add_f32_dpp v209, v209, v209 row_ror:4 row_mask:0xf bank_mask:0xf
    v_add_f32_dpp v210, v210, v210 row_ror:4 row_mask:0xf bank_mask:0xf
    v_add_f32_dpp v211, v211, v211 row_ror:4 row_mask:0xf bank_mask:0xf
    v_add_f32_dpp v208, v208, v208 row_ror:8 row_mask:0xf bank_mask:0xf
    v_add_f32_dpp v209, v209, v209 row_ror:8 row_mask:0xf bank_mask:0xf
    v_add_f32_dpp v210, v210, v210 row_ror:8 row_mask:0xf bank_mask:0xf
    v_add_f32_dpp v211, v211, v211 row_ror:8 row_mask:0xf bank_mask:0xf
    v_mov_b32 v212, v208
    v_mov_b32 v213, v209
    v_mov_b32 v214, v210
    v_mov_b32 v215, v211
    s_nop 0
    v_permlane16_swap_b32 v208, v212
    v_permlane16_swap_b32 v209, v213
    v_permlane16_swap_b32 v210, v214
    v_permlane16_swap_b32 v211, v215
    v_add_f32 v208, v208, v212
    v_add_f32 v209, v209, v213
    v_add_f32 v210, v210, v214
    v_add_f32 v211, v211, v215
    v_cvt_pk_bf16_f32 v208, v208, v208
    v_and_b32 v208, 0xffff0000, v208
    v_cvt_pk_bf16_f32 v209, v209, v209
    v_and_b32 v209, 0xffff0000, v209
    v_cvt_pk_bf16_f32 v210, v210, v210
    v_and_b32 v210, 0xffff0000, v210
    v_cvt_pk_bf16_f32 v211, v211, v211
    v_and_b32 v211, 0xffff0000, v211
    v_mul_f32 v212, 0xbfb8aa3b, v208
    v_mul_f32 v213, 0xbfb8aa3b, v209
    v_mul_f32 v214, 0xbfb8aa3b, v210
    v_mul_f32 v215, 0xbfb8aa3b, v211
    v_exp_f32 v212, v212
    v_exp_f32 v213, v213
    v_exp_f32 v214, v214
    v_exp_f32 v215, v215
    s_nop 0
    v_add_f32 v212, 1.0, v212
    v_add_f32 v213, 1.0, v213
    v_add_f32 v214, 1.0, v214
    v_add_f32 v215, 1.0, v215
    v_rcp_f32 v212, v212
    v_rcp_f32 v213, v213
    v_rcp_f32 v214, v214
    v_rcp_f32 v215, v215
    s_nop 0
    v_mul_f32 v208, v208, v212
    v_mul_f32 v209, v209, v213
    v_mul_f32 v210, v210, v214
    v_mul_f32 v211, v211, v215
    v_cvt_pk_bf16_f32 v212, v208, v209
    v_cvt_pk_bf16_f32 v213, v210, v211
    v_and_b32 v14, 1, v2
    v_and_b32 v15, 1, v3
    v_lshlrev_b32 v14, 3, v14
    v_lshl_add_u32 v57, v15, 2, v14
    ds_bpermute_b32 v214, v57, v212
    ds_bpermute_b32 v216, v57, v213
    s_mov_b32 s48, 0x00030003
    s_mov_b32 s49, 0x00300030
    s_mov_b32 s50, 0x03000300
    s_mov_b32 s51, 0x30003000
    v_lshl_add_u32 v14, v15, 2, v4
    v_mul_u32_u24 v60, 896, v14
    v_lshrrev_b32 v14, 1, v3
    v_lshl_add_u32 v60, v14, 5, v60
    v_lshl_add_u32 v60, v5, 3, v60
    v_mul_u32_u24 v63, 3584, v15
    v_add_u32 v63, v63, v60
    v_add_u32 v63, 49152, v63
    v_add_u32 v60, 32768, v60
    s_waitcnt lgkmcnt(0)
    v_cndmask_b32 v250, 0, v214, s[48:49]
    v_cndmask_b32 v251, 0, v216, s[48:49]
    v_cndmask_b32 v252, 0, v214, s[50:51]
    v_cndmask_b32 v253, 0, v216, s[50:51]
    v_mov_b32 v211, v6
    v_mov_b32 v215, v6
    v_mov_b32 v219, v6
    v_mov_b32 v223, v6
    v_lshrrev_b32 v57, 2, v1
    v_mul_u32_u24 v61, 5120, v57
    v_lshl_add_u32 v61, v5, 4, v61
    v_lshrrev_b32 v58, 5, v1
    v_lshl_add_u32 v58, v58, 2, v4
    v_lshlrev_b32 v58, 12, v58
    v_lshl_add_u32 v58, v15, 6, v58
    v_lshl_add_u32 v58, v5, 4, v58
    v_add_u32 v57, 155648, v56
    v_mov_b64 v[44:45], v[206:207]
    v_mov_b64 v[46:47], v[254:255]
    v_mov_b32 v48, v6
    v_mov_b32 v49, v58
    v_mov_b32 v50, v60
    v_mov_b32 v51, v63
    ds_write_b128 v57, v[250:253]
    ds_write_b128 v57, v[44:47] offset:1024
    ds_write_b128 v57, v[48:51] offset:2048
    s_and_b32 s44, s2, 7
    s_lshl_b32 s44, s44, 4
    s_bfe_u32 s46, s2, 0x40003
    s_or_b32 s44, s44, s46
    s_and_b32 s46, s2, 0x80
    s_or_b32 s44, s44, s46
    s_lshl_b32 s44, s44, 12
    s_add_u32 s44, s44, 0x100000
    s_andn2_b32 s47, s2, 15
    s_and_b32 s43, s2, 7
    s_lshl_b32 s43, s43, 1
    s_or_b32 s47, s47, s43
    s_bfe_u32 s43, s2, 0x10003
    s_or_b32 s47, s47, s43
    s_lshl_b32 s47, s47, 3
    s_lshr_b32 s43, s2, 4
    s_mul_i32 s43, s43, 3
    v_lshrrev_b32 v14, 1, v3
    v_lshl_add_u32 v14, v15, 1, v14
    v_add_u32 v14, s43, v14
    v_and_b32 v62, 1, v14
    v_mul_u32_u24 v62, 896, v62
    v_cmp_lt_u32 vcc, 13, v14
    v_lshrrev_b32 v14, 1, v14
    v_lshl_add_u32 v62, v14, 7, v62
    v_lshl_add_u32 v62, v5, 1, v62
    v_mov_b32 v14, 0x10000
    v_cndmask_b32 v62, v62, v14, vcc
    s_and_b32 s46, s47, 0x78
    s_add_u32 s43, s44, 0x500000
.p2align 6
.Lvtile:
    ds_read_b128 v[44:47], v245
    v_add_u32 v245, 128, v245
    v_add_u32 v20, s82, v10
    v_xor_b32 v21, 32, v20
    v_xor_b32 v22, 64, v20
    v_xor_b32 v23, 96, v20
    v_xor_b32 v24, 128, v20
    v_xor_b32 v25, 160, v20
    v_xor_b32 v26, 192, v20
    v_xor_b32 v27, 224, v20
    s_waitcnt lgkmcnt(0)
    v_lshlrev_b32 v36, 16, v44
    v_and_b32 v37, 0xffff0000, v44
    v_lshlrev_b32 v38, 16, v45
    v_and_b32 v39, 0xffff0000, v45
    v_lshlrev_b32 v40, 16, v46
    v_and_b32 v41, 0xffff0000, v46
    v_lshlrev_b32 v42, 16, v47
    v_and_b32 v43, 0xffff0000, v47
    v_fma_f32 v48, v36, s84, -v12
    v_fma_f32 v49, v37, s84, -v12
    v_fma_f32 v50, v38, s84, -v12
    v_fma_f32 v51, v39, s84, -v12
    v_fma_f32 v52, v40, s84, -v12
    v_fma_f32 v53, v41, s84, -v12
    v_fma_f32 v54, v42, s84, -v12
    v_fma_f32 v55, v43, s84, -v12
    v_exp_f32 v48, v48
    v_exp_f32 v49, v49
    v_exp_f32 v50, v50
    v_exp_f32 v51, v51
    v_exp_f32 v52, v52
    v_exp_f32 v53, v53
    v_exp_f32 v54, v54
    v_exp_f32 v55, v55
    s_nop 0
    v_cvt_pk_bf16_f32 v44, v48, v49
    v_cvt_pk_bf16_f32 v45, v50, v51
    v_cvt_pk_bf16_f32 v46, v52, v53
    v_cvt_pk_bf16_f32 v47, v54, v55
    v_add_f32 v13, v13, v48
    v_add_f32 v49, v49, v50
    v_add_f32 v51, v51, v52
    v_add_f32 v53, v53, v54
    v_add_f32 v13, v13, v55
    v_add_f32 v49, v49, v51
    v_add_f32 v13, v13, v53
    v_add_f32 v13, v13, v49
    s_mov_b64 exec, s[64:65]
    v_mov_b64 v[160:161], v[44:45]
    v_mov_b64 v[162:163], v[46:47]
    s_mov_b64 exec, s[66:67]
    v_mov_b64 v[164:165], v[44:45]
    v_mov_b64 v[166:167], v[46:47]
    s_mov_b64 exec, s[68:69]
    v_mov_b64 v[168:169], v[44:45]
    v_mov_b64 v[170:171], v[46:47]
    s_mov_b64 exec, s[70:71]
    v_mov_b64 v[172:173], v[44:45]
    v_mov_b64 v[174:175], v[46:47]
    s_mov_b64 exec, s[72:73]
    v_mov_b64 v[176:177], v[44:45]
    v_mov_b64 v[178:179], v[46:47]
    s_mov_b64 exec, s[74:75]
    v_mov_b64 v[180:181], v[44:45]
    v_mov_b64 v[182:183], v[46:47]
    s_mov_b64 exec, s[76:77]
    v_mov_b64 v[184:185], v[44:45]
    v_mov_b64 v[186:187], v[46:47]
    s_mov_b64 exec, s[78:79]
    v_mov_b64 v[188:189], v[44:45]
    v_mov_b64 v[190:191], v[46:47]
    s_mov_b64 exec, -1
    s_cmp_ge_u32 s83, s85
    s_cbranch_scc1 .Lpd_13
.Lps_14:
    ds_read_b32 v14, v7
    s_waitcnt lgkmcnt(0)
    v_readfirstlane_b32 s83, v14
    s_cmp_ge_u32 s83, s85
    s_cbranch_scc1 .Lpd_13
    s_sleep 1
    s_sub_u32 s80, s80, 1
    s_cbranch_scc0 .Lps_14
    s_mov_b32 s80, 0
.Lpd_13:
    ds_read_b64_tr_b16 v[64:65], v20 offset:0
    ds_read_b64_tr_b16 v[66:67], v20 offset:8192
    ds_read_b64_tr_b16 v[68:69], v20 offset:256
    ds_read_b64_tr_b16 v[70:71], v20 offset:8448
    ds_read_b64_tr_b16 v[72:73], v21 offset:0
    ds_read_b64_tr_b16 v[74:75], v21 offset:8192
    ds_read_b64_tr_b16 v[76:77], v21 offset:256
    ds_read_b64_tr_b16 v[78:79], v21 offset:8448
    ds_read_b64_tr_b16 v[80:81], v22 offset:0
    ds_read_b64_tr_b16 v[82:83], v22 offset:8192
    ds_read_b64_tr_b16 v[84:85], v22 offset:256
    ds_read_b64_tr_b16 v[86:87], v22 offset:8448
    ds_read_b64_tr_b16 v[88:89], v23 offset:0
    ds_read_b64_tr_b16 v[90:91], v23 offset:8192
    s_add_u32 s85, s85, 1
    s_or_b32 s15, s85, s23
    v_mov_b32 v14, s15
    s_waitcnt lgkmcnt(12)
    v_mfma_f32_16x16x32_bf16 v[28:31], v[160:163], v[64:67], v[28:31]
    ds_read_b64_tr_b16 v[92:93], v23 offset:256
    ds_read_b64_tr_b16 v[94:95], v23 offset:8448
    s_waitcnt lgkmcnt(12)
    v_mfma_f32_16x16x32_bf16 v[32:35], v[160:163], v[68:71], v[32:35]
    ds_read_b64_tr_b16 v[96:97], v24 offset:0
    ds_read_b64_tr_b16 v[98:99], v24 offset:8192
    s_waitcnt lgkmcnt(12)
    v_mfma_f32_16x16x32_bf16 v[28:31], v[164:167], v[72:75], v[28:31]
    ds_read_b64_tr_b16 v[100:101], v24 offset:256
    ds_read_b64_tr_b16 v[102:103], v24 offset:8448
    s_waitcnt lgkmcnt(12)
    v_mfma_f32_16x16x32_bf16 v[32:35], v[164:167], v[76:79], v[32:35]
    ds_read_b64_tr_b16 v[104:105], v25 offset:0
    ds_read_b64_tr_b16 v[106:107], v25 offset:8192
    s_waitcnt lgkmcnt(12)
    v_mfma_f32_16x16x32_bf16 v[28:31], v[168:171], v[80:83], v[28:31]
    ds_read_b64_tr_b16 v[108:109], v25 offset:256
    ds_read_b64_tr_b16 v[110:111], v25 offset:8448
    s_waitcnt lgkmcnt(12)
    v_mfma_f32_16x16x32_bf16 v[32:35], v[168:171], v[84:87], v[32:35]
    ds_read_b64_tr_b16 v[112:113], v26 offset:0
    ds_read_b64_tr_b16 v[114:115], v26 offset:8192
    s_waitcnt lgkmcnt(12)
    v_mfma_f32_16x16x32_bf16 v[28:31], v[172:175], v[88:91], v[28:31]
    ds_read_b64_tr_b16 v[116:117], v26 offset:256
    ds_read_b64_tr_b16 v[118:119], v26 offset:8448
    s_waitcnt lgkmcnt(12)
    v_mfma_f32_16x16x32_bf16 v[32:35], v[172:175], v[92:95], v[32:35]
    ds_read_b64_tr_b16 v[120:121], v27 offset:0
    ds_read_b64_tr_b16 v[122:123], v27 offset:8192
    s_waitcnt lgkmcnt(12)
    v_mfma_f32_16x16x32_bf16 v[28:31], v[176:179], v[96:99], v[28:31]
    ds_read_b64_tr_b16 v[124:125], v27 offset:256
    ds_read_b64_tr_b16 v[126:127], v27 offset:8448
    s_waitcnt lgkmcnt(12)
    v_mfma_f32_16x16x32_bf16 v[32:35], v[176:179], v[100:103], v[32:35]
    s_waitcnt lgkmcnt(10)
    v_mfma_f32_16x16x32_bf16 v[28:31], v[180:183], v[104:107], v[28:31]
    s_waitcnt lgkmcnt(8)
    v_mfma_f32_16x16x32_bf16 v[32:35], v[180:183], v[108:111], v[32:35]
    s_waitcnt lgkmcnt(6)
    v_mfma_f32_16x16x32_bf16 v[28:31], v[184:187], v[112:115], v[28:31]
    s_waitcnt lgkmcnt(4)
    v_mfma_f32_16x16x32_bf16 v[32:35], v[184:187], v[116:119], v[32:35]
    s_waitcnt lgkmcnt(2)
    v_mfma_f32_16x16x32_bf16 v[28:31], v[188:191], v[120:123], v[28:31]
    s_waitcnt lgkmcnt(0)
    ds_write_b32 v8, v14
    v_mfma_f32_16x16x32_bf16 v[32:35], v[188:191], v[124:127], v[32:35]
    s_add_u32 s82, s82, 0x4000
    s_cmp_eq_u32 s82, 0x24000
    s_cselect_b32 s82, 0, s82
    s_cmp_gt_u32 s85, 116
    s_cbranch_scc1 .Lvlast
    s_bitcmp0_b64 s[38:39], s85
    s_cbranch_scc1 .Lvtile
    s_xor_b32 s24, s8, 0x1100
    s_load_dword s24, s[52:53], s24
    s_xor_b32 s25, s8, 0x1900
    s_load_dword s25, s[52:53], s25
    s_xor_b32 s26, s8, 0x2200
    s_load_dword s26, s[52:53], s26
    s_xor_b32 s27, s8, 0x2a00
    s_load_dword s27, s[52:53], s27
    s_xor_b32 s28, s8, 0x4300
    s_load_dword s28, s[52:53], s28
    s_xor_b32 s29, s8, 0x4b00
    s_load_dword s29, s[52:53], s29
    s_xor_b32 s30, s8, 0x8400
    s_load_dword s30, s[52:53], s30
    s_xor_b32 s31, s8, 0x8c00
    s_load_dword s31, s[52:53], s31
    s_xor_b32 s32, s8, 0x3500
    s_load_dword s32, s[52:53], s32
    s_xor_b32 s33, s8, 0x3d00
    s_load_dword s33, s[52:53], s33
    s_xor_b32 s34, s8, 0xc600
    s_load_dword s34, s[52:53], s34
    s_xor_b32 s35, s8, 0xce00
    s_load_dword s35, s[52:53], s35
    s_xor_b32 s56, s8, 0xf700
    s_load_dword s56, s[52:53], s56
    s_xor_b32 s57, s8, 0xff00
    s_load_dword s57, s[52:53], s57
    s_mov_b64 exec, 1
    buffer_store_dword v6, v59, s[16:19], s21 offen sc1
    s_mov_b64 exec, -1
    s_cmp_lg_u32 s85, 108
    s_cbranch_scc1 .Lsk_15
    v_lshlrev_b32 v14, 6, v1
    buffer_load_dword v246, v14, s[16:19], s44 offen sc1
.Lsk_15:
    s_add_u32 s21, s21, 0x10000
    s_mov_b32 s15, 0
    s_waitcnt lgkmcnt(0)
    s_add_u32 s52, s52, 0x10000
    s_addc_u32 s53, s53, 0
    s_cmp_eq_u32 s24, s20
    s_addc_u32 s15, s15, 0
    s_cmp_eq_u32 s25, s20
    s_addc_u32 s15, s15, 0
    s_cmp_eq_u32 s26, s20
    s_addc_u32 s15, s15, 0
    s_cmp_eq_u32 s27, s20
    s_addc_u32 s15, s15, 0
    s_cmp_eq_u32 s28, s20
    s_addc_u32 s15, s15, 0
    s_cmp_eq_u32 s29, s20
    s_addc_u32 s15, s15, 0
    s_cmp_eq_u32 s30, s20
    s_addc_u32 s15, s15, 0
    s_cmp_eq_u32 s31, s20
    s_addc_u32 s15, s15, 0
    s_cmp_eq_u32 s32, s20
    s_addc_u32 s15, s15, 0
    s_cmp_eq_u32 s33, s20
    s_addc_u32 s15, s15, 0
    s_cmp_eq_u32 s34, s20
    s_addc_u32 s15, s15, 0
    s_cmp_eq_u32 s35, s20
    s_addc_u32 s15, s15, 0
    s_cmp_eq_u32 s56, s20
    s_addc_u32 s15, s15, 0
    s_cmp_eq_u32 s57, s20
    s_addc_u32 s15, s15, 0
    s_mov_b32 s23, 0
    s_cmp_ge_u32 s15, 3
    s_cselect_b32 s23, 0x10000, s23
    s_cmp_ge_u32 s15, 6
    s_cselect_b32 s23, 0x20000, s23
    s_cmp_ge_u32 s15, 10
    s_cselect_b32 s23, 0x30000, s23
    s_cmp_ge_u32 s15, 12
    s_cselect_b32 s23, 0x40000, s23
    s_cmp_ge_u32 s15, 13
    s_cselect_b32 s23, 0x50000, s23
    s_branch .Lvtile
.Lvlast:
    s_cmp_le_u32 s85, 128
    s_cbranch_scc1 .Lvtile
    v_mov_b32 v15, v13
    s_mov_b32 vcc_lo, 0xf0f0f0f0
    s_mov_b32 vcc_hi, 0xf0f0f0f0
    v_permlane16_swap_b32 v13, v15
    v_add_f32 v13, v13, v15
    v_mov_b32 v15, v13
    v_mov_b64 v[208:209], v[28:29]
    v_mov_b64 v[216:217], v[30:31]
    v_permlane32_swap_b32 v13, v15
    v_add_f32 v13, v13, v15
    v_cndmask_b32 v15, v12, v13, vcc
    v_mov_b64 v[212:213], v[32:33]
    v_mov_b64 v[220:221], v[34:35]
    v_mov_b32_dpp v210, v15 quad_perm:[0,0,0,0] row_mask:0xf bank_mask:0xf
    buffer_store_dwordx4 v[208:211], v56, s[16:19], s44 offen offset:0
    v_mov_b32_dpp v214, v15 quad_perm:[0,0,0,0] row_mask:0xf bank_mask:0xf
    buffer_store_dwordx4 v[212:215], v56, s[16:19], s44 offen offset:1024
    v_mov_b32_dpp v218, v15 quad_perm:[2,2,2,2] row_mask:0xf bank_mask:0xf
    buffer_store_dwordx4 v[216:219], v56, s[16:19], s44 offen offset:2048
    v_mov_b32_dpp v222, v15 quad_perm:[2,2,2,2] row_mask:0xf bank_mask:0xf
    buffer_store_dwordx4 v[220:223], v56, s[16:19], s44 offen offset:3072
    buffer_store_dwordx4 v[208:211], v56, s[16:19], s43 offen offset:0 sc1
    buffer_store_dwordx4 v[212:215], v56, s[16:19], s43 offen offset:1024 sc1
    buffer_store_dwordx4 v[216:219], v56, s[16:19], s43 offen offset:2048 sc1
    buffer_store_dwordx4 v[220:223], v56, s[16:19], s43 offen offset:3072 sc1
    s_cmp_ge_u32 s2, 80
    s_cbranch_scc1 .Lfin
    v_not_b32 v67, v6
    v_not_b32 v71, v6
    v_not_b32 v75, v6
    v_not_b32 v79, v6
    v_not_b32 v83, v6
    v_not_b32 v87, v6
    v_not_b32 v91, v6
    v_not_b32 v95, v6
    v_not_b32 v99, v6
    v_not_b32 v103, v6
    v_not_b32 v107, v6
    v_not_b32 v111, v6
    v_not_b32 v115, v6
    v_not_b32 v119, v6
    v_not_b32 v123, v6
    v_not_b32 v127, v6
    s_lshl_b32 s64, s47, 3
    s_add_u32 s64, s64, 0x200000
    s_add_u32 s65, s64, 0x14000
    s_add_u32 s66, s64, 0x28000
    s_add_u32 s67, s64, 0x3c000
    s_add_u32 s68, s64, 0x50000
    s_add_u32 s69, s64, 0x64000
    s_add_u32 s70, s64, 0x78000
    s_add_u32 s71, s64, 0x8c000
    s_add_u32 s72, s64, 0xa0000
    s_add_u32 s73, s64, 0xb4000
    s_add_u32 s74, s64, 0xc8000
    s_add_u32 s75, s64, 0xdc000
    s_add_u32 s76, s64, 0xf0000
    s_add_u32 s77, s64, 0x104000
    s_add_u32 s78, s64, 0x118000
    s_add_u32 s79, s64, 0x12c000
    s_mov_b32 s85, 0x10000
    s_cmp_ge_u32 s83, s85
    s_cbranch_scc1 .Lpd_16
.Lps_17:
    ds_read_b32 v14, v7
    s_waitcnt lgkmcnt(0)
    v_readfirstlane_b32 s83, v14
    s_cmp_ge_u32 s83, s85
    s_cbranch_scc1 .Lpd_16
    s_sleep 1
    s_sub_u32 s80, s80, 1
    s_cbranch_scc0 .Lps_17
    s_mov_b32 s80, 0
.Lpd_16:
    buffer_load_dwordx4 v[64:67], v61, s[16:19], s64 offen sc1
    buffer_load_dwordx4 v[68:71], v61, s[16:19], s65 offen sc1
    buffer_load_dwordx4 v[72:75], v61, s[16:19], s66 offen sc1
    buffer_load_dwordx4 v[76:79], v61, s[16:19], s67 offen sc1
    buffer_load_dwordx4 v[80:83], v61, s[16:19], s68 offen sc1
    buffer_load_dwordx4 v[84:87], v61, s[16:19], s69 offen sc1
    buffer_load_dwordx4 v[88:91], v61, s[16:19], s70 offen sc1
    buffer_load_dwordx4 v[92:95], v61, s[16:19], s71 offen sc1
    buffer_load_dwordx4 v[96:99], v61, s[16:19], s72 offen sc1
    buffer_load_dwordx4 v[100:103], v61, s[16:19], s73 offen sc1
    buffer_load_dwordx4 v[104:107], v61, s[16:19], s74 offen sc1
    buffer_load_dwordx4 v[108:111], v61, s[16:19], s75 offen sc1
    buffer_load_dwordx4 v[112:115], v61, s[16:19], s76 offen sc1
    buffer_load_dwordx4 v[116:119], v61, s[16:19], s77 offen sc1
    buffer_load_dwordx4 v[120:123], v61, s[16:19], s78 offen sc1
    buffer_load_dwordx4 v[124:127], v61, s[16:19], s79 offen sc1
.Lh2_loop:
    s_waitcnt vmcnt(0)
    v_cmp_ne_u32 s[8:9], v67, v6
    v_cmp_ne_u32 s[10:11], v71, v6
    v_cmp_ne_u32 s[12:13], v75, v6
    v_cmp_ne_u32 s[14:15], v79, v6
    v_cmp_ne_u32 s[20:21], v83, v6
    v_cmp_ne_u32 s[22:23], v87, v6
    v_cmp_ne_u32 s[24:25], v91, v6
    v_cmp_ne_u32 s[26:27], v95, v6
    v_cmp_ne_u32 s[28:29], v99, v6
    v_cmp_ne_u32 s[30:31], v103, v6
    v_cmp_ne_u32 s[32:33], v107, v6
    v_cmp_ne_u32 s[34:35], v111, v6
    v_cmp_ne_u32 s[36:37], v115, v6
    v_cmp_ne_u32 s[38:39], v119, v6
    v_cmp_ne_u32 s[40:41], v123, v6
    v_cmp_ne_u32 s[42:43], v127, v6
    s_or_b64 vcc, s[8:9], s[10:11]
    s_or_b64 vcc, vcc, s[12:13]
    s_or_b64 vcc, vcc, s[14:15]
    s_or_b64 vcc, vcc, s[20:21]
    s_or_b64 vcc, vcc, s[22:23]
    s_or_b64 vcc, vcc, s[24:25]
    s_or_b64 vcc, vcc, s[26:27]
    s_or_b64 vcc, vcc, s[28:29]
    s_or_b64 vcc, vcc, s[30:31]
    s_or_b64 vcc, vcc, s[32:33]
    s_or_b64 vcc, vcc, s[34:35]
    s_or_b64 vcc, vcc, s[36:37]
    s_or_b64 vcc, vcc, s[38:39]
    s_or_b64 vcc, vcc, s[40:41]
    s_or_b64 vcc, vcc, s[42:43]
    s_cbranch_scc0 .Lh2_ok
    s_or_b64 exec, s[8:9], s[10:11]
    s_cbranch_execz .Lsk_18
    s_wqm_b64 exec, exec
    buffer_load_dwordx4 v[64:67], v61, s[16:19], s64 offen sc1
    buffer_load_dwordx4 v[68:71], v61, s[16:19], s65 offen sc1
.Lsk_18:
    s_or_b64 exec, s[12:13], s[14:15]
    s_cbranch_execz .Lsk_19
    s_wqm_b64 exec, exec
    buffer_load_dwordx4 v[72:75], v61, s[16:19], s66 offen sc1
    buffer_load_dwordx4 v[76:79], v61, s[16:19], s67 offen sc1
.Lsk_19:
    s_or_b64 exec, s[20:21], s[22:23]
    s_cbranch_execz .Lsk_20
    s_wqm_b64 exec, exec
    buffer_load_dwordx4 v[80:83], v61, s[16:19], s68 offen sc1
    buffer_load_dwordx4 v[84:87], v61, s[16:19], s69 offen sc1
.Lsk_20:
    s_or_b64 exec, s[24:25], s[26:27]
    s_cbranch_execz .Lsk_21
    s_wqm_b64 exec, exec
    buffer_load_dwordx4 v[88:91], v61, s[16:19], s70 offen sc1
    buffer_load_dwordx4 v[92:95], v61, s[16:19], s71 offen sc1
.Lsk_21:
    s_or_b64 exec, s[28:29], s[30:31]
    s_cbranch_execz .Lsk_22
    s_wqm_b64 exec, exec
    buffer_load_dwordx4 v[96:99], v61, s[16:19], s72 offen sc1
    buffer_load_dwordx4 v[100:103], v61, s[16:19], s73 offen sc1
.Lsk_22:
    s_or_b64 exec, s[32:33], s[34:35]
    s_cbranch_execz .Lsk_23
    s_wqm_b64 exec, exec
    buffer_load_dwordx4 v[104:107], v61, s[16:19], s74 offen sc1
    buffer_load_dwordx4 v[108:111], v61, s[16:19], s75 offen sc1
.Lsk_23:
    s_or_b64 exec, s[36:37], s[38:39]
    s_cbranch_execz .Lsk_24
    s_wqm_b64 exec, exec
    buffer_load_dwordx4 v[112:115], v61, s[16:19], s76 offen sc1
    buffer_load_dwordx4 v[116:119], v61, s[16:19], s77 offen sc1
.Lsk_24:
    s_or_b64 exec, s[40:41], s[42:43]
    s_cbranch_execz .Lsk_25
    s_wqm_b64 exec, exec
    buffer_load_dwordx4 v[120:123], v61, s[16:19], s78 offen sc1
    buffer_load_dwordx4 v[124:127], v61, s[16:19], s79 offen sc1
.Lsk_25:
    s_mov_b64 exec, -1
    s_sub_u32 s80, s80, 16
    s_cbranch_scc0 .Lh2_loop
    s_mov_b32 s80, 0
.Lh2_ok:
    v_pk_add_f32 v[36:37], v[64:65], v[68:69]
    v_pk_add_f32 v[38:39], v[72:73], v[76:77]
    v_pk_add_f32 v[40:41], v[80:81], v[84:85]
    v_pk_add_f32 v[42:43], v[88:89], v[92:93]
    v_pk_add_f32 v[44:45], v[96:97], v[100:101]
    v_pk_add_f32 v[46:47], v[104:105], v[108:109]
    v_pk_add_f32 v[48:49], v[112:113], v[116:117]
    v_pk_add_f32 v[50:51], v[120:121], v[124:125]
    v_pk_add_f32 v[36:37], v[36:37], v[44:45]
    v_pk_add_f32 v[38:39], v[38:39], v[46:47]
    v_pk_add_f32 v[40:41], v[40:41], v[48:49]
    v_pk_add_f32 v[42:43], v[42:43], v[50:51]
    v_add_f32 v16, v66, v70
    v_add_f32 v17, v74, v78
    v_add_f32 v18, v82, v86
    v_add_f32 v19, v90, v94
    v_add_f32 v20, v98, v102
    v_add_f32 v21, v106, v110
    v_add_f32 v22, v114, v118
    v_add_f32 v23, v122, v126
    v_pk_add_f32 v[36:37], v[36:37], v[38:39]
    v_pk_add_f32 v[40:41], v[40:41], v[42:43]
    v_pk_add_f32 v[16:17], v[16:17], v[18:19]
    v_pk_add_f32 v[20:21], v[20:21], v[22:23]
    v_pk_add_f32 v[36:37], v[36:37], v[40:41]
    v_pk_add_f32 v[16:17], v[16:17], v[20:21]
    s_nop 0
    v_permlane32_swap_b32 v36, v37
    v_permlane32_swap_b32 v16, v17
    v_add_f32 v36, v36, v37
    v_add_f32 v16, v16, v17
    v_mov_b32 v17, v16
    s_nop 1
    v_permlane32_swap_b32 v16, v17
    v_add_f32 v16, v16, v17
    s_nop 1
    v_permlane16_swap_b32 v36, v16
    v_add_f32 v36, v36, v16
    s_nop 1
    v_add_f32_dpp v36, v36, v36 row_ror:4 row_mask:0xf bank_mask:0xf
    s_nop 1
    v_add_f32_dpp v36, v36, v36 row_ror:8 row_mask:0xf bank_mask:0xf
    v_cvt_pk_bf16_f32 v36, v36, v36
    s_mov_b32 exec_lo, 0x000f000f
    s_mov_b32 exec_hi, 0xf
    buffer_store_short v36, v62, s[60:63], s46 offen
    s_cmp_lg_u32 s2, 0
    s_cbranch_scc1 .Lfin
    s_mov_b64 exec, 1
    buffer_store_dword v6, v59, s[16:19], 0 offen
.Lfin:
.Lexit:
    s_endpgm
.section .rodata,"a"
.p2align 6
.amdhsa_kernel gated_mix__gqa_block_cached__dense_activation_silu__decode_kernel
  .amdhsa_next_free_vgpr 256
  .amdhsa_next_free_sgpr 102
  .amdhsa_accum_offset 256
  .amdhsa_group_segment_fixed_size 0
  .amdhsa_kernarg_size 96
  .amdhsa_user_sgpr_count 2
  .amdhsa_user_sgpr_kernarg_segment_ptr 1
  .amdhsa_system_sgpr_workgroup_id_x 1
  .amdhsa_float_denorm_mode_32 3
.end_amdhsa_kernel
```
